```python
import torch

def _softmax(x, axis=-1):
    return torch.softmax(x, dim=axis)
def _gelu(x):
    return torch.nn.functional.gelu(x, approximate="tanh")
def _silu(x):
    return torch.nn.functional.silu(x)
def _sigmoid(x):
    return torch.sigmoid(x)
def _layernorm(x, axis=-1, eps=1e-5):
    m = x.mean(dim=axis, keepdim=True)
    v = x.var(dim=axis, keepdim=True, unbiased=False)
    return (x - m) / torch.sqrt(v + eps)
def _scatter_add(tgt, idx, src, axis=0):
    return tgt.clone().index_add_(axis, idx, src)
def _segment_sum(src, seg, n):
    out = torch.zeros((n,) + src.shape[1:], dtype=src.dtype)
    return out.index_add_(0, seg, src)
def _pad(x, pw):
    flat = tuple(v for pair in reversed(pw) for v in pair)
    return torch.nn.functional.pad(x, flat)

kernel_name = 'standalone__gqa_block_cached__near_ridge'

def setup_inputs():

    _w = (lambda a: (lambda t: t.to(torch.bfloat16) if t.is_floating_point() else t)(torch.as_tensor(a)))
    B, Sq, D = 16, 32, 512
    Hq, Hkv, Sk, Dh = 32, 8, 512, 128
    assert Hq % Hkv == 0, (Hq, Hkv)
    return {
        "x": _w((lambda *s: torch.randn(*s, dtype=torch.bfloat16) * 0.8)(B, Sq, D)),
        "k_cache": _w((lambda *s: torch.randn(*s, dtype=torch.bfloat16) * 0.8)(B, Hkv, Sk, Dh)),
        "v_cache": _w((lambda *s: torch.randn(*s, dtype=torch.bfloat16) * 0.05)(B, Hkv, Sk, Dh)),
        "wq": _w((lambda *s: torch.randn(*s, dtype=torch.bfloat16) * 0.8)(D, Hq * Dh) * (D ** -0.5)),
        "wo": _w((lambda *s: torch.randn(*s, dtype=torch.bfloat16) * 0.05)(Hq * Dh, D) * ((Hq * Dh) ** -0.5)),
    }

def reference(x, k_cache, v_cache, wq, wo):
    B, Sq, D = x.shape
    Hq, Dh = 32, 128
    Hkv = k_cache.shape[1]
    rep = Hq // Hkv
    q = (lambda x, *d: x.permute(*d))((x @ wq).reshape(B, Sq, Hq, Dh), 0, 2, 1, 3)
    k = (lambda x, n, axis: torch.repeat_interleave(x, n, dim=axis))(k_cache, rep, axis=1)
    v = (lambda x, n, axis: torch.repeat_interleave(x, n, dim=axis))(v_cache, rep, axis=1)
    scores = torch.einsum("bhqd,bhkd->bhqk", q, k) * (Dh ** -0.5)
    p = _softmax(scores, axis=-1)
    o = torch.einsum("bhqk,bhkd->bhqd", p, v)
    return (lambda x, *d: x.permute(*d))(o, 0, 2, 1, 3).reshape(B, Sq, Hq * Dh) @ wo
```

```asm
; @launch grid=(256,1,1) block=(512,1,1) lds=163840
.amdgcn_target "amdgcn-amd-amdhsa--gfx950"
.text
.globl standalone__gqa_block_cached__near_ridge_kernel
.p2align 12
.p2align 8
.type standalone__gqa_block_cached__near_ridge_kernel,@function
standalone__gqa_block_cached__near_ridge_kernel:
    s_cmp_ge_u32 s2, 256
    s_cbranch_scc1 L_end
    s_load_dwordx16 s[4:19], s[0:1], 0
    v_lshrrev_b32 v2, 6, v0
    v_and_b32 v1, 63, v0
    v_readfirstlane_b32 s52, v2
    s_and_b32 s54, s2, 7
    s_lshr_b32 s53, s2, 4
    s_bfe_u32 s55, s2, 0x10003
    s_and_b32 s56, s2, 15
    s_mov_b32 s22, 0x80000
    s_mov_b32 s23, 0x00020000
    s_mov_b32 s34, 0x400000
    s_mov_b32 s35, 0x00020000
    s_mov_b32 s26, 0x1000000
    s_mov_b32 s27, 0x00020000
    s_mov_b32 s30, 0x1000000
    s_mov_b32 s31, 0x00020000
    s_mov_b32 s38, 0x400000
    s_mov_b32 s39, 0x00020000
    s_mov_b32 s42, 0x80000
    s_mov_b32 s43, 0x00020000
    s_mov_b32 s46, 0x100
    s_mov_b32 s47, 0x00020000
    s_mov_b32 s50, 0x10000000
    s_mov_b32 s51, 0x00020000
    s_and_b32 s68, s52, 3
    s_cmp_ge_u32 s52, 4
    s_cbranch_scc1 L_loader
    s_cmp_lg_u32 s52, 1
    s_cbranch_scc1 L_pcC1
    s_call_b64 s[78:79], L_pad1
L_pcC1:
    s_cmp_lg_u32 s52, 2
    s_cbranch_scc1 L_pcC2
    s_call_b64 s[78:79], L_pad2
L_pcC2:
    s_cmp_lg_u32 s52, 3
    s_cbranch_scc1 L_pcC3
    s_call_b64 s[78:79], L_pad3
L_pcC3:
    s_branch L_compute
L_loader:
    s_lshl_b32 s64, s55, 3
    s_add_u32 s57, s53, s64
    s_and_b32 s57, s57, 14
    s_lshl_b32 s58, s57, 18
    s_lshl_b32 s65, s54, 1
    s_add_u32 s65, s65, s55
    s_lshl_b32 s66, s65, 9
    s_lshl_b32 s67, s53, 15
    s_lshl_b32 s63, s68, 11
    v_lshrrev_b32 v3, 4, v1
    v_lshl_add_u32 v3, s68, 3, v3
    v_and_b32 v4, 15, v1
    v_xor_b32 v5, v3, v4
    v_and_b32 v5, 15, v5
    v_xor_b32 v6, 4, v5
    v_lshl_add_u32 v20, s57, 2, v5
    v_lshl_add_u32 v21, s57, 2, v6
    v_lshl_add_u32 v22, v3, 10, s67
    v_add_u32 v23, 3072, v22
    v_lshrrev_b32 v7, 4, v1
    v_lshlrev_b32 v7, 2, v7
    v_xor_b32 v7, v7, v4
    v_lshlrev_b32 v7, 4, v7
    v_lshrrev_b32 v9, 4, v1
    v_lshlrev_b32 v9, 1, v9
    v_xor_b32 v9, v9, v4
    s_and_b32 s64, s68, 1
    s_lshl_b32 s64, s64, 3
    v_xor_b32 v18, s64, v9
    v_lshlrev_b32 v18, 4, v18
    v_lshl_add_u32 v13, v3, 13, v18
    v_add_u32 v13, s66, v13
    v_add_u32 v14, 31744, v13
    s_waitcnt lgkmcnt(0)
    s_mov_b32 s20, s4
    s_and_b32 s21, s5, 0xffff
    s_mov_b32 s32, s10
    s_and_b32 s33, s11, 0xffff
    s_add_u32 m0, s63, 0
    s_nop 0
    buffer_load_dwordx4 v13, s[32:35], s58 offen offset:0 lds
    buffer_load_dwordx4 v14, s[32:35], s58 offen offset:1024 lds
    s_add_u32 m0, s63, 7936
    s_nop 0
    buffer_load_dwordx4 v13, s[32:35], s58 offen offset:256 lds
    buffer_load_dwordx4 v14, s[32:35], s58 offen offset:1280 lds
    s_add_u32 m0, s63, 16384
    s_add_u32 s58, s58, 0x40000
    s_and_b32 s58, s58, 0x3fffff
    buffer_load_dwordx4 v13, s[32:35], s58 offen offset:0 lds
    buffer_load_dwordx4 v14, s[32:35], s58 offen offset:1024 lds
    s_add_u32 m0, s63, 24320
    s_nop 0
    buffer_load_dwordx4 v13, s[32:35], s58 offen offset:256 lds
    buffer_load_dwordx4 v14, s[32:35], s58 offen offset:1280 lds
    s_add_u32 m0, s63, 131072
    v_and_b32 v24, 63, v20
    v_lshl_add_u32 v24, v24, 4, v22
    buffer_load_dwordx4 v24, s[20:23], 0 offen offset:0 lds
    v_and_b32 v25, 63, v21
    v_lshl_add_u32 v25, v25, 4, v23
    buffer_load_dwordx4 v25, s[20:23], 0 offen offset:1024 lds
    s_mov_b32 s24, s6
    s_and_b32 s25, s7, 0xffff
    s_mov_b32 s28, s8
    s_and_b32 s29, s9, 0xffff
    s_mov_b32 s36, s12
    s_and_b32 s37, s13, 0xffff
    s_mov_b32 s40, s14
    s_and_b32 s41, s15, 0xffff
    s_mov_b32 s44, s16
    s_and_b32 s45, s17, 0xffff
    s_mov_b32 s48, s18
    s_and_b32 s49, s19, 0xffff
    s_lshl_b32 s64, s53, 3
    s_add_u32 s64, s64, s54
    s_lshl_b32 s64, s64, 17
    v_lshl_add_u32 v8, v3, 8, s64
    v_lshl_add_u32 v10, v5, 4, v8
    v_lshl_add_u32 v11, v6, 4, v8
    v_lshl_add_u32 v12, v9, 4, v8
    v_xor_b32 v19, 0x80, v12
    s_lshl_b32 s65, s65, 18
    v_lshl_add_u32 v15, v3, 10, v7
    v_add_u32 v15, s65, v15
    v_add_u32 v16, 3072, v15
    s_lshr_b32 s60, s53, 1
    s_lshl_b32 s60, s60, 15
    s_and_b32 s61, s53, 1
    s_lshl_b32 s61, s61, 9
    s_add_u32 s62, s61, 256
    s_add_u32 m0, s63, 139264
    v_add_u32 v20, 16, v20
    v_and_b32 v24, 63, v20
    v_lshl_add_u32 v24, v24, 4, v22
    buffer_load_dwordx4 v24, s[20:23], 0 offen offset:0 lds
    v_add_u32 v21, 16, v21
    v_and_b32 v25, 63, v21
    v_lshl_add_u32 v25, v25, 4, v23
    buffer_load_dwordx4 v25, s[20:23], 0 offen offset:1024 lds
    s_add_u32 m0, s63, 32768
    s_add_u32 s58, s58, 0x40000
    s_and_b32 s58, s58, 0x3fffff
    buffer_load_dwordx4 v13, s[32:35], s58 offen offset:0 lds
    buffer_load_dwordx4 v14, s[32:35], s58 offen offset:1024 lds
    s_waitcnt vmcnt(12)
    s_add_u32 m0, s63, 40704
    s_nop 0
    buffer_load_dwordx4 v13, s[32:35], s58 offen offset:256 lds
    buffer_load_dwordx4 v14, s[32:35], s58 offen offset:1280 lds
    s_waitcnt vmcnt(12)
    s_add_u32 m0, s63, 49152
    s_add_u32 s58, s58, 0x40000
    s_and_b32 s58, s58, 0x3fffff
    buffer_load_dwordx4 v13, s[32:35], s58 offen offset:0 lds
    buffer_load_dwordx4 v14, s[32:35], s58 offen offset:1024 lds
    s_waitcnt vmcnt(12)
    s_add_u32 m0, s63, 57088
    s_nop 0
    buffer_load_dwordx4 v13, s[32:35], s58 offen offset:256 lds
    buffer_load_dwordx4 v14, s[32:35], s58 offen offset:1280 lds
    s_waitcnt vmcnt(10)
    s_barrier
    s_add_u32 m0, s63, 65536
    s_add_u32 s58, s58, 0x40000
    s_and_b32 s58, s58, 0x3fffff
    buffer_load_dwordx4 v13, s[32:35], s58 offen offset:0 lds
    buffer_load_dwordx4 v14, s[32:35], s58 offen offset:1024 lds
    s_add_u32 m0, s63, 73472
    s_nop 0
    buffer_load_dwordx4 v13, s[32:35], s58 offen offset:256 lds
    buffer_load_dwordx4 v14, s[32:35], s58 offen offset:1280 lds
    s_waitcnt vmcnt(12)
    s_add_u32 m0, s63, 81920
    s_add_u32 s58, s58, 0x40000
    s_and_b32 s58, s58, 0x3fffff
    buffer_load_dwordx4 v13, s[32:35], s58 offen offset:0 lds
    buffer_load_dwordx4 v14, s[32:35], s58 offen offset:1024 lds
    s_waitcnt vmcnt(12)
    s_add_u32 m0, s63, 89856
    s_nop 0
    buffer_load_dwordx4 v13, s[32:35], s58 offen offset:256 lds
    buffer_load_dwordx4 v14, s[32:35], s58 offen offset:1280 lds
    s_waitcnt vmcnt(12)
    s_add_u32 m0, s63, 98304
    s_add_u32 s58, s58, 0x40000
    s_and_b32 s58, s58, 0x3fffff
    buffer_load_dwordx4 v13, s[32:35], s58 offen offset:0 lds
    buffer_load_dwordx4 v14, s[32:35], s58 offen offset:1024 lds
    s_waitcnt vmcnt(12)
    s_add_u32 m0, s63, 106240
    s_nop 0
    buffer_load_dwordx4 v13, s[32:35], s58 offen offset:256 lds
    buffer_load_dwordx4 v14, s[32:35], s58 offen offset:1280 lds
    s_waitcnt vmcnt(12)
    s_add_u32 m0, s63, 114688
    s_add_u32 s58, s58, 0x40000
    s_and_b32 s58, s58, 0x3fffff
    buffer_load_dwordx4 v13, s[32:35], s58 offen offset:0 lds
    buffer_load_dwordx4 v14, s[32:35], s58 offen offset:1024 lds
    s_barrier
    s_waitcnt vmcnt(12)
    s_add_u32 m0, s63, 122624
    s_nop 0
    buffer_load_dwordx4 v13, s[32:35], s58 offen offset:256 lds
    buffer_load_dwordx4 v14, s[32:35], s58 offen offset:1280 lds
    s_waitcnt vmcnt(12)
    s_add_u32 m0, s63, 147456
    v_add_u32 v20, 16, v20
    v_and_b32 v24, 63, v20
    v_lshl_add_u32 v24, v24, 4, v22
    buffer_load_dwordx4 v24, s[20:23], 0 offen offset:0 lds
    v_add_u32 v21, 16, v21
    v_and_b32 v25, 63, v21
    v_lshl_add_u32 v25, v25, 4, v23
    buffer_load_dwordx4 v25, s[20:23], 0 offen offset:1024 lds
    s_waitcnt vmcnt(12)
    s_add_u32 m0, s63, 0
    s_add_u32 s58, s58, 0x40000
    s_and_b32 s58, s58, 0x3fffff
    buffer_load_dwordx4 v13, s[32:35], s58 offen offset:0 lds
    buffer_load_dwordx4 v14, s[32:35], s58 offen offset:1024 lds
    s_waitcnt vmcnt(12)
    s_add_u32 m0, s63, 7936
    s_nop 0
    buffer_load_dwordx4 v13, s[32:35], s58 offen offset:256 lds
    buffer_load_dwordx4 v14, s[32:35], s58 offen offset:1280 lds
    s_barrier
    s_waitcnt vmcnt(12)
    s_add_u32 m0, s63, 16384
    s_add_u32 s58, s58, 0x40000
    s_and_b32 s58, s58, 0x3fffff
    buffer_load_dwordx4 v13, s[32:35], s58 offen offset:0 lds
    buffer_load_dwordx4 v14, s[32:35], s58 offen offset:1024 lds
    s_waitcnt vmcnt(12)
    s_add_u32 m0, s63, 24320
    s_nop 0
    buffer_load_dwordx4 v13, s[32:35], s58 offen offset:256 lds
    buffer_load_dwordx4 v14, s[32:35], s58 offen offset:1280 lds
    s_waitcnt vmcnt(12)
    s_add_u32 m0, s63, 32768
    s_add_u32 s58, s58, 0x40000
    s_and_b32 s58, s58, 0x3fffff
    buffer_load_dwordx4 v13, s[32:35], s58 offen offset:0 lds
    buffer_load_dwordx4 v14, s[32:35], s58 offen offset:1024 lds
    s_waitcnt vmcnt(12)
    s_add_u32 m0, s63, 40704
    s_nop 0
    buffer_load_dwordx4 v13, s[32:35], s58 offen offset:256 lds
    buffer_load_dwordx4 v14, s[32:35], s58 offen offset:1280 lds
    s_barrier
    s_waitcnt vmcnt(12)
    s_add_u32 m0, s63, 49152
    s_add_u32 s58, s58, 0x40000
    s_and_b32 s58, s58, 0x3fffff
    buffer_load_dwordx4 v13, s[32:35], s58 offen offset:0 lds
    buffer_load_dwordx4 v14, s[32:35], s58 offen offset:1024 lds
    s_waitcnt vmcnt(12)
    s_add_u32 m0, s63, 57088
    s_nop 0
    buffer_load_dwordx4 v13, s[32:35], s58 offen offset:256 lds
    buffer_load_dwordx4 v14, s[32:35], s58 offen offset:1280 lds
    s_waitcnt vmcnt(12)
    s_add_u32 m0, s63, 155648
    v_add_u32 v20, 16, v20
    v_and_b32 v24, 63, v20
    v_lshl_add_u32 v24, v24, 4, v22
    buffer_load_dwordx4 v24, s[20:23], 0 offen offset:0 lds
    v_add_u32 v21, 16, v21
    v_and_b32 v25, 63, v21
    v_lshl_add_u32 v25, v25, 4, v23
    buffer_load_dwordx4 v25, s[20:23], 0 offen offset:1024 lds
    s_waitcnt vmcnt(12)
    s_add_u32 m0, s63, 65536
    s_add_u32 s58, s58, 0x40000
    s_and_b32 s58, s58, 0x3fffff
    buffer_load_dwordx4 v13, s[32:35], s58 offen offset:0 lds
    buffer_load_dwordx4 v14, s[32:35], s58 offen offset:1024 lds
    s_waitcnt vmcnt(12)
    s_add_u32 m0, s63, 73472
    s_nop 0
    buffer_load_dwordx4 v13, s[32:35], s58 offen offset:256 lds
    buffer_load_dwordx4 v14, s[32:35], s58 offen offset:1280 lds
    s_barrier
    s_waitcnt vmcnt(12)
    s_add_u32 m0, s63, 81920
    s_add_u32 s58, s58, 0x40000
    s_and_b32 s58, s58, 0x3fffff
    buffer_load_dwordx4 v13, s[32:35], s58 offen offset:0 lds
    buffer_load_dwordx4 v14, s[32:35], s58 offen offset:1024 lds
    s_waitcnt vmcnt(12)
    s_add_u32 m0, s63, 89856
    s_nop 0
    buffer_load_dwordx4 v13, s[32:35], s58 offen offset:256 lds
    buffer_load_dwordx4 v14, s[32:35], s58 offen offset:1280 lds
    s_waitcnt vmcnt(12)
    s_add_u32 m0, s63, 98304
    s_add_u32 s58, s58, 0x40000
    s_and_b32 s58, s58, 0x3fffff
    buffer_load_dwordx4 v13, s[32:35], s58 offen offset:0 lds
    buffer_load_dwordx4 v14, s[32:35], s58 offen offset:1024 lds
    s_waitcnt vmcnt(12)
    s_add_u32 m0, s63, 106240
    s_nop 0
    buffer_load_dwordx4 v13, s[32:35], s58 offen offset:256 lds
    buffer_load_dwordx4 v14, s[32:35], s58 offen offset:1280 lds
    s_barrier
    s_waitcnt vmcnt(12)
    s_add_u32 m0, s63, 114688
    s_add_u32 s58, s58, 0x40000
    s_and_b32 s58, s58, 0x3fffff
    buffer_load_dwordx4 v13, s[32:35], s58 offen offset:0 lds
    buffer_load_dwordx4 v14, s[32:35], s58 offen offset:1024 lds
    s_waitcnt vmcnt(12)
    s_add_u32 m0, s63, 122624
    s_nop 0
    buffer_load_dwordx4 v13, s[32:35], s58 offen offset:256 lds
    buffer_load_dwordx4 v14, s[32:35], s58 offen offset:1280 lds
    s_waitcnt vmcnt(12)
    s_add_u32 m0, s63, 0
    s_mov_b32 s59, 0
    buffer_load_dwordx4 v10, s[24:27], s59 offen offset:0  lds
    buffer_load_dwordx4 v11, s[24:27], s59 offen offset:1024  lds
    s_waitcnt vmcnt(12)
    s_add_u32 m0, s63, 8192
    s_mov_b32 s59, 8192
    buffer_load_dwordx4 v10, s[24:27], s59 offen offset:0  lds
    buffer_load_dwordx4 v11, s[24:27], s59 offen offset:1024  lds
    s_waitcnt vmcnt(12)
    s_barrier
    s_add_u32 m0, s63, 16384
    s_mov_b32 s59, 16384
    buffer_load_dwordx4 v10, s[24:27], s59 offen offset:0  lds
    buffer_load_dwordx4 v11, s[24:27], s59 offen offset:1024  lds
    s_waitcnt vmcnt(12)
    s_add_u32 m0, s63, 24576
    s_mov_b32 s59, 24576
    buffer_load_dwordx4 v10, s[24:27], s59 offen offset:0  lds
    buffer_load_dwordx4 v11, s[24:27], s59 offen offset:1024  lds
    s_waitcnt vmcnt(12)
    s_add_u32 m0, s63, 32768
    s_mov_b32 s59, 32768
    buffer_load_dwordx4 v10, s[24:27], s59 offen offset:0  lds
    buffer_load_dwordx4 v11, s[24:27], s59 offen offset:1024  lds
    s_waitcnt vmcnt(10)
    s_barrier
    s_waitcnt vmcnt(8)
    s_add_u32 m0, s63, 40960
    s_mov_b32 s59, 40960
    buffer_load_dwordx4 v10, s[24:27], s59 offen offset:0  lds
    buffer_load_dwordx4 v11, s[24:27], s59 offen offset:1024  lds
    s_waitcnt vmcnt(8)
    s_add_u32 m0, s63, 49152
    s_mov_b32 s59, 49152
    buffer_load_dwordx4 v10, s[24:27], s59 offen offset:0  lds
    buffer_load_dwordx4 v11, s[24:27], s59 offen offset:1024  lds
    s_waitcnt vmcnt(8)
    s_add_u32 m0, s63, 57344
    s_mov_b32 s59, 57344
    buffer_load_dwordx4 v10, s[24:27], s59 offen offset:0  lds
    buffer_load_dwordx4 v11, s[24:27], s59 offen offset:1024  lds
    s_waitcnt vmcnt(8)
    s_add_u32 m0, s63, 65536
    s_mov_b32 s59, 65536
    buffer_load_dwordx4 v10, s[24:27], s59 offen offset:0  lds
    buffer_load_dwordx4 v11, s[24:27], s59 offen offset:1024  lds
    s_barrier
    s_waitcnt vmcnt(8)
    s_add_u32 m0, s63, 73728
    s_mov_b32 s59, 73728
    buffer_load_dwordx4 v10, s[24:27], s59 offen offset:0  lds
    buffer_load_dwordx4 v11, s[24:27], s59 offen offset:1024  lds
    s_waitcnt vmcnt(8)
    s_add_u32 m0, s63, 81920
    s_mov_b32 s59, 81920
    buffer_load_dwordx4 v10, s[24:27], s59 offen offset:0  lds
    buffer_load_dwordx4 v11, s[24:27], s59 offen offset:1024  lds
    s_waitcnt vmcnt(8)
    s_add_u32 m0, s63, 90112
    s_mov_b32 s59, 90112
    buffer_load_dwordx4 v10, s[24:27], s59 offen offset:0  lds
    buffer_load_dwordx4 v11, s[24:27], s59 offen offset:1024  lds
    s_waitcnt vmcnt(8)
    s_add_u32 m0, s63, 98304
    s_mov_b32 s59, 98304
    buffer_load_dwordx4 v10, s[24:27], s59 offen offset:0  lds
    buffer_load_dwordx4 v11, s[24:27], s59 offen offset:1024  lds
    s_barrier
    s_waitcnt vmcnt(8)
    s_add_u32 m0, s63, 106496
    s_mov_b32 s59, 106496
    buffer_load_dwordx4 v10, s[24:27], s59 offen offset:0  lds
    buffer_load_dwordx4 v11, s[24:27], s59 offen offset:1024  lds
    s_waitcnt vmcnt(8)
    s_add_u32 m0, s63, 114688
    s_mov_b32 s59, 114688
    buffer_load_dwordx4 v10, s[24:27], s59 offen offset:0  lds
    buffer_load_dwordx4 v11, s[24:27], s59 offen offset:1024  lds
    s_waitcnt vmcnt(8)
    s_add_u32 m0, s63, 122880
    s_mov_b32 s59, 122880
    buffer_load_dwordx4 v10, s[24:27], s59 offen offset:0  lds
    buffer_load_dwordx4 v11, s[24:27], s59 offen offset:1024  lds
    s_waitcnt vmcnt(8)
    s_add_u32 m0, s63, 0
    s_mov_b32 s59, 0
    buffer_load_dwordx4 v12, s[28:31], s59 offen offset:0  lds
    buffer_load_dwordx4 v19, s[28:31], s59 offen offset:1024  lds
    s_barrier
    s_waitcnt vmcnt(8)
    s_add_u32 m0, s63, 8192
    s_mov_b32 s59, 8192
    buffer_load_dwordx4 v12, s[28:31], s59 offen offset:0  lds
    buffer_load_dwordx4 v19, s[28:31], s59 offen offset:1024  lds
    s_waitcnt vmcnt(8)
    s_add_u32 m0, s63, 16384
    s_mov_b32 s59, 16384
    buffer_load_dwordx4 v12, s[28:31], s59 offen offset:0  lds
    buffer_load_dwordx4 v19, s[28:31], s59 offen offset:1024  lds
    s_waitcnt vmcnt(8)
    s_add_u32 m0, s63, 24576
    s_mov_b32 s59, 24576
    buffer_load_dwordx4 v12, s[28:31], s59 offen offset:0  lds
    buffer_load_dwordx4 v19, s[28:31], s59 offen offset:1024  lds
    s_waitcnt vmcnt(8)
    s_add_u32 m0, s63, 32768
    s_mov_b32 s59, 32768
    buffer_load_dwordx4 v12, s[28:31], s59 offen offset:0  lds
    buffer_load_dwordx4 v19, s[28:31], s59 offen offset:1024  lds
    s_barrier
    s_waitcnt vmcnt(8)
    s_add_u32 m0, s63, 40960
    s_mov_b32 s59, 40960
    buffer_load_dwordx4 v12, s[28:31], s59 offen offset:0  lds
    buffer_load_dwordx4 v19, s[28:31], s59 offen offset:1024  lds
    s_waitcnt vmcnt(8)
    s_add_u32 m0, s63, 49152
    s_mov_b32 s59, 49152
    buffer_load_dwordx4 v12, s[28:31], s59 offen offset:0  lds
    buffer_load_dwordx4 v19, s[28:31], s59 offen offset:1024  lds
    s_waitcnt vmcnt(8)
    s_add_u32 m0, s63, 57344
    s_mov_b32 s59, 57344
    buffer_load_dwordx4 v12, s[28:31], s59 offen offset:0  lds
    buffer_load_dwordx4 v19, s[28:31], s59 offen offset:1024  lds
    s_waitcnt vmcnt(8)
    s_add_u32 m0, s63, 65536
    s_mov_b32 s59, 65536
    buffer_load_dwordx4 v12, s[28:31], s59 offen offset:0  lds
    buffer_load_dwordx4 v19, s[28:31], s59 offen offset:1024  lds
    s_barrier
    s_waitcnt vmcnt(8)
    s_add_u32 m0, s63, 73728
    s_mov_b32 s59, 73728
    buffer_load_dwordx4 v12, s[28:31], s59 offen offset:0  lds
    buffer_load_dwordx4 v19, s[28:31], s59 offen offset:1024  lds
    s_waitcnt vmcnt(8)
    s_add_u32 m0, s63, 81920
    s_mov_b32 s59, 81920
    buffer_load_dwordx4 v12, s[28:31], s59 offen offset:0  lds
    buffer_load_dwordx4 v19, s[28:31], s59 offen offset:1024  lds
    s_waitcnt vmcnt(8)
    s_add_u32 m0, s63, 90112
    s_mov_b32 s59, 90112
    buffer_load_dwordx4 v12, s[28:31], s59 offen offset:0  lds
    buffer_load_dwordx4 v19, s[28:31], s59 offen offset:1024  lds
    s_waitcnt vmcnt(8)
    s_add_u32 m0, s63, 98304
    s_mov_b32 s59, 98304
    buffer_load_dwordx4 v12, s[28:31], s59 offen offset:0  lds
    buffer_load_dwordx4 v19, s[28:31], s59 offen offset:1024  lds
    s_barrier
    s_waitcnt vmcnt(8)
    s_add_u32 m0, s63, 106496
    s_mov_b32 s59, 106496
    buffer_load_dwordx4 v12, s[28:31], s59 offen offset:0  lds
    buffer_load_dwordx4 v19, s[28:31], s59 offen offset:1024  lds
    s_waitcnt vmcnt(8)
    s_add_u32 m0, s63, 114688
    s_mov_b32 s59, 114688
    buffer_load_dwordx4 v12, s[28:31], s59 offen offset:0  lds
    buffer_load_dwordx4 v19, s[28:31], s59 offen offset:1024  lds
    s_waitcnt vmcnt(8)
    s_add_u32 m0, s63, 122880
    s_mov_b32 s59, 122880
    buffer_load_dwordx4 v12, s[28:31], s59 offen offset:0  lds
    buffer_load_dwordx4 v19, s[28:31], s59 offen offset:1024  lds
    s_waitcnt vmcnt(8)
    s_add_u32 m0, s63, 147456
    s_add_u32 s59, s60, s61
    buffer_load_dwordx4 v15, s[36:39], s59 offen offset:0 lds
    buffer_load_dwordx4 v16, s[36:39], s59 offen offset:1024 lds
    s_barrier
    s_waitcnt vmcnt(8)
    s_add_u32 m0, s63, 155648
    s_add_u32 s59, s60, s62
    buffer_load_dwordx4 v15, s[36:39], s59 offen offset:0 lds
    buffer_load_dwordx4 v16, s[36:39], s59 offen offset:1024 lds
    s_waitcnt vmcnt(8)
    s_add_u32 m0, s63, 0
    s_add_u32 s60, s60, 0x8000
    s_and_b32 s60, s60, 0x3ffff
    s_add_u32 s59, s60, s61
    buffer_load_dwordx4 v15, s[36:39], s59 offen offset:0 lds
    buffer_load_dwordx4 v16, s[36:39], s59 offen offset:1024 lds
    s_barrier
    s_waitcnt vmcnt(8)
    s_add_u32 m0, s63, 8192
    s_add_u32 s59, s60, s62
    buffer_load_dwordx4 v15, s[36:39], s59 offen offset:0 lds
    buffer_load_dwordx4 v16, s[36:39], s59 offen offset:1024 lds
    s_waitcnt vmcnt(8)
    s_add_u32 m0, s63, 16384
    s_add_u32 s60, s60, 0x8000
    s_and_b32 s60, s60, 0x3ffff
    s_add_u32 s59, s60, s61
    buffer_load_dwordx4 v15, s[36:39], s59 offen offset:0 lds
    buffer_load_dwordx4 v16, s[36:39], s59 offen offset:1024 lds
    s_barrier
    v_mov_b32 v2, 0
    s_lshl_b32 s64, s53, 2
    buffer_load_dword v17, v2, s[44:47], s64 offen offset:128 sc1
    buffer_load_dword v17, v2, s[44:47], s64 offen offset:128 sc1
    s_waitcnt vmcnt(8)
    s_add_u32 m0, s63, 24576
    s_add_u32 s59, s60, s62
    buffer_load_dwordx4 v15, s[36:39], s59 offen offset:0 lds
    buffer_load_dwordx4 v16, s[36:39], s59 offen offset:1024 lds
    s_waitcnt vmcnt(8)
    s_add_u32 m0, s63, 32768
    s_add_u32 s60, s60, 0x8000
    s_and_b32 s60, s60, 0x3ffff
    s_add_u32 s59, s60, s61
    buffer_load_dwordx4 v15, s[36:39], s59 offen offset:0 lds
    buffer_load_dwordx4 v16, s[36:39], s59 offen offset:1024 lds
    s_waitcnt vmcnt(8)
    s_add_u32 m0, s63, 40960
    s_add_u32 s59, s60, s62
    buffer_load_dwordx4 v15, s[36:39], s59 offen offset:0 lds
    buffer_load_dwordx4 v16, s[36:39], s59 offen offset:1024 lds
    s_waitcnt vmcnt(8)
    s_add_u32 m0, s63, 49152
    s_add_u32 s60, s60, 0x8000
    s_and_b32 s60, s60, 0x3ffff
    s_add_u32 s59, s60, s61
    buffer_load_dwordx4 v15, s[36:39], s59 offen offset:0 lds
    buffer_load_dwordx4 v16, s[36:39], s59 offen offset:1024 lds
    s_waitcnt vmcnt(8)
    s_add_u32 m0, s63, 57344
    s_add_u32 s59, s60, s62
    buffer_load_dwordx4 v15, s[36:39], s59 offen offset:0 lds
    buffer_load_dwordx4 v16, s[36:39], s59 offen offset:1024 lds
    s_waitcnt vmcnt(8)
    s_add_u32 m0, s63, 65536
    s_add_u32 s60, s60, 0x8000
    s_and_b32 s60, s60, 0x3ffff
    s_add_u32 s59, s60, s61
    buffer_load_dwordx4 v15, s[36:39], s59 offen offset:0 lds
    buffer_load_dwordx4 v16, s[36:39], s59 offen offset:1024 lds
    s_barrier
    s_add_u32 m0, s63, 73728
    s_add_u32 s59, s60, s62
    buffer_load_dwordx4 v15, s[36:39], s59 offen offset:0 lds
    buffer_load_dwordx4 v16, s[36:39], s59 offen offset:1024 lds
    s_add_u32 m0, s63, 81920
    s_add_u32 s60, s60, 0x8000
    s_and_b32 s60, s60, 0x3ffff
    s_add_u32 s59, s60, s61
    buffer_load_dwordx4 v15, s[36:39], s59 offen offset:0 lds
    buffer_load_dwordx4 v16, s[36:39], s59 offen offset:1024 lds
    s_waitcnt vmcnt(12)
    s_add_u32 m0, s63, 90112
    s_add_u32 s59, s60, s62
    buffer_load_dwordx4 v15, s[36:39], s59 offen offset:0 lds
    buffer_load_dwordx4 v16, s[36:39], s59 offen offset:1024 lds
    s_waitcnt vmcnt(12)
    s_add_u32 m0, s63, 98304
    s_add_u32 s60, s60, 0x8000
    s_and_b32 s60, s60, 0x3ffff
    s_add_u32 s59, s60, s61
    buffer_load_dwordx4 v15, s[36:39], s59 offen offset:0 lds
    buffer_load_dwordx4 v16, s[36:39], s59 offen offset:1024 lds
    s_barrier
    s_mov_b32 s70, 200000
L_rdy:
    v_cmp_eq_u32 vcc, 1, v17
    s_cbranch_vccnz L_rdy_ok
    s_lshl_b32 s64, s53, 2
    buffer_load_dword v17, v2, s[44:47], s64 offen offset:128 sc1
    s_waitcnt vmcnt(0)
    s_sub_u32 s70, s70, 1
    s_cmp_lg_u32 s70, 0
    s_cbranch_scc1 L_rdy
L_rdy_ok:
    s_waitcnt vmcnt(12)
    s_add_u32 m0, s63, 106496
    s_add_u32 s59, s60, s62
    buffer_load_dwordx4 v15, s[36:39], s59 offen offset:0 lds
    buffer_load_dwordx4 v16, s[36:39], s59 offen offset:1024 lds
    s_waitcnt vmcnt(12)
    s_add_u32 m0, s63, 114688
    s_xor_b32 s61, s61, 512
    s_xor_b32 s62, s62, 512
    s_add_u32 s60, s60, 0x8000
    s_and_b32 s60, s60, 0x3ffff
    s_add_u32 s59, s60, s61
    buffer_load_dwordx4 v15, s[36:39], s59 offen offset:0 lds
    buffer_load_dwordx4 v16, s[36:39], s59 offen offset:1024 lds
    s_waitcnt vmcnt(12)
    s_add_u32 m0, s63, 122880
    s_add_u32 s59, s60, s62
    buffer_load_dwordx4 v15, s[36:39], s59 offen offset:0 lds
    buffer_load_dwordx4 v16, s[36:39], s59 offen offset:1024 lds
    s_waitcnt vmcnt(12)
    s_add_u32 m0, s63, 147456
    s_add_u32 s60, s60, 0x8000
    s_and_b32 s60, s60, 0x3ffff
    s_add_u32 s59, s60, s61
    buffer_load_dwordx4 v15, s[36:39], s59 offen offset:0 lds
    buffer_load_dwordx4 v16, s[36:39], s59 offen offset:1024 lds
    s_barrier
    s_waitcnt vmcnt(12)
    s_add_u32 m0, s63, 155648
    s_add_u32 s59, s60, s62
    buffer_load_dwordx4 v15, s[36:39], s59 offen offset:0 lds
    buffer_load_dwordx4 v16, s[36:39], s59 offen offset:1024 lds
    s_waitcnt vmcnt(12)
    s_add_u32 m0, s63, 0
    s_add_u32 s60, s60, 0x8000
    s_and_b32 s60, s60, 0x3ffff
    s_add_u32 s59, s60, s61
    s_branch L_pad0x
.p2align 12
L_pad0:
    s_setpc_b64 s[78:79]
    s_nop 0
L_pad0x:
    buffer_load_dwordx4 v15, s[36:39], s59 offen offset:0 lds
    buffer_load_dwordx4 v16, s[36:39], s59 offen offset:1024 lds
    s_waitcnt vmcnt(12)
    s_add_u32 m0, s63, 8192
    s_add_u32 s59, s60, s62
    buffer_load_dwordx4 v15, s[36:39], s59 offen offset:0 lds
    buffer_load_dwordx4 v16, s[36:39], s59 offen offset:1024 lds
    s_waitcnt vmcnt(12)
    s_add_u32 m0, s63, 16384
    s_add_u32 s60, s60, 0x8000
    s_and_b32 s60, s60, 0x3ffff
    s_add_u32 s59, s60, s61
    buffer_load_dwordx4 v15, s[36:39], s59 offen offset:0 lds
    buffer_load_dwordx4 v16, s[36:39], s59 offen offset:1024 lds
    s_barrier
    s_waitcnt vmcnt(12)
    s_add_u32 m0, s63, 24576
    s_add_u32 s59, s60, s62
    buffer_load_dwordx4 v15, s[36:39], s59 offen offset:0 lds
    buffer_load_dwordx4 v16, s[36:39], s59 offen offset:1024 lds
    s_waitcnt vmcnt(12)
    s_add_u32 m0, s63, 32768
    s_add_u32 s60, s60, 0x8000
    s_and_b32 s60, s60, 0x3ffff
    s_add_u32 s59, s60, s61
    buffer_load_dwordx4 v15, s[36:39], s59 offen offset:0 lds
    buffer_load_dwordx4 v16, s[36:39], s59 offen offset:1024 lds
    s_waitcnt vmcnt(12)
    s_add_u32 m0, s63, 40960
    s_add_u32 s59, s60, s62
    buffer_load_dwordx4 v15, s[36:39], s59 offen offset:0 lds
    buffer_load_dwordx4 v16, s[36:39], s59 offen offset:1024 lds
    s_waitcnt vmcnt(12)
    s_add_u32 m0, s63, 49152
    s_add_u32 s60, s60, 0x8000
    s_and_b32 s60, s60, 0x3ffff
    s_add_u32 s59, s60, s61
    buffer_load_dwordx4 v15, s[36:39], s59 offen offset:0 lds
    buffer_load_dwordx4 v16, s[36:39], s59 offen offset:1024 lds
    s_barrier
    s_waitcnt vmcnt(12)
    s_add_u32 m0, s63, 57344
    s_add_u32 s59, s60, s62
    buffer_load_dwordx4 v15, s[36:39], s59 offen offset:0 lds
    buffer_load_dwordx4 v16, s[36:39], s59 offen offset:1024 lds
    s_waitcnt vmcnt(12)
    s_add_u32 m0, s63, 65536
    s_add_u32 s60, s60, 0x8000
    s_and_b32 s60, s60, 0x3ffff
    s_add_u32 s59, s60, s61
    buffer_load_dwordx4 v15, s[36:39], s59 offen offset:0 lds
    buffer_load_dwordx4 v16, s[36:39], s59 offen offset:1024 lds
    s_waitcnt vmcnt(12)
    s_add_u32 m0, s63, 73728
    s_add_u32 s59, s60, s62
    buffer_load_dwordx4 v15, s[36:39], s59 offen offset:0 lds
    buffer_load_dwordx4 v16, s[36:39], s59 offen offset:1024 lds
    s_waitcnt vmcnt(12)
    s_add_u32 m0, s63, 81920
    s_add_u32 s60, s60, 0x8000
    s_and_b32 s60, s60, 0x3ffff
    s_add_u32 s59, s60, s61
    buffer_load_dwordx4 v15, s[36:39], s59 offen offset:0 lds
    buffer_load_dwordx4 v16, s[36:39], s59 offen offset:1024 lds
    s_barrier
    s_waitcnt vmcnt(12)
    s_add_u32 m0, s63, 90112
    s_add_u32 s59, s60, s62
    buffer_load_dwordx4 v15, s[36:39], s59 offen offset:0 lds
    buffer_load_dwordx4 v16, s[36:39], s59 offen offset:1024 lds
    s_waitcnt vmcnt(8)
    s_barrier
    s_waitcnt vmcnt(0)
    s_barrier
    s_waitcnt lgkmcnt(0)
    v_and_b32 v23, 15, v1
    v_lshlrev_b32 v24, 2, v23
    v_lshrrev_b32 v25, 4, v1
    v_mul_u32_u24 v26, 1024, v25
    v_lshl_add_u32 v26, v23, 4, v26
    v_and_b32 v27, 7, v1
    v_lshlrev_b32 v27, 10, v27
    v_bfe_u32 v28, v1, 3, 1
    v_lshl_add_u32 v27, v28, 3, v27
    v_lshrrev_b32 v28, 1, v25
    v_lshl_add_u32 v27, v28, 4, v27
    v_and_b32 v28, 1, v25
    v_lshl_add_u32 v27, v28, 2, v27
    s_mul_i32 s64, s53, 524288
    s_mul_i32 s75, s2, 256
    s_add_u32 s75, s75, 16777216
    v_mov_b32 v29, 131072
    v_mov_b32 v22, 1
    s_mul_i32 s65, s56, 32768
    s_add_u32 s65, s65, s64
    s_lshl_b32 s66, s68, 8
    s_add_u32 s65, s65, s66
    s_lshr_b32 s64, s56, 3
    s_lshl_b32 s66, s53, 1
    s_add_u32 s64, s64, s66
    s_and_b32 s64, s64, 3
    s_lshl_b32 s64, s64, 8
    s_bfe_u32 s66, s56, 0x10002
    s_lshl_b32 s66, s66, 7
    s_add_u32 s64, s64, s66
    s_lshl_b32 s66, s68, 5
    s_add_u32 s64, s64, s66
    s_lshl_b32 s66, s53, 15
    s_add_u32 s64, s64, s66
    s_and_b32 s66, s56, 3
    s_lshl_b32 s66, s66, 13
    s_add_u32 s64, s64, s66
    s_mov_b32 s67, 0xffff0000
    s_mov_b32 s70, 200000
    s_barrier
    s_branch L_poll
L_compute:
    s_mov_b32 s69, 0x3e0293ee
    v_lshlrev_b32 v3, 4, v1
    v_add_u32 v5, 0x20000, v3
    v_and_b32 v64, 15, v1
    v_lshrrev_b32 v65, 4, v1
    v_xor_b32 v66, v64, v65
    v_lshlrev_b32 v66, 4, v66
    v_lshl_add_u32 v66, v64, 8, v66
    v_xor_b32 v22, 0, v66
    v_xor_b32 v23, 64, v66
    v_xor_b32 v24, 128, v66
    v_xor_b32 v25, 192, v66
    s_and_b32 s64, s68, 1
    s_lshl_b32 s65, s64, 12
    s_add_u32 s65, s65, 131072
    v_add_u32 v26, s65, v22
    v_add_u32 v27, s65, v23
    v_add_u32 v28, s65, v24
    v_add_u32 v29, s65, v25
    v_bfe_u32 v67, v1, 2, 2
    v_and_b32 v69, 3, v1
    v_and_b32 v68, 1, v65
    v_lshl_add_u32 v68, v68, 2, v67
    v_lshlrev_b32 v68, 5, v68
    v_lshl_add_u32 v68, v69, 3, v68
    v_lshl_add_u32 v68, v67, 8, v68
    v_lshl_add_u32 v62, v65, 10, v68
    v_lshl_add_u32 v70, v65, 11, v68
    s_lshr_b32 s65, s68, 1
    s_lshl_b32 s65, s65, 13
    v_add_u32 v70, s65, v70
    v_xor_b32 v32, 0, v70
    v_add_u32 v40, 0x10000, v32
    v_xor_b32 v33, 32, v70
    v_add_u32 v41, 0x10000, v33
    v_xor_b32 v34, 64, v70
    v_add_u32 v42, 0x10000, v34
    v_xor_b32 v35, 96, v70
    v_add_u32 v43, 0x10000, v35
    v_xor_b32 v36, 128, v70
    v_add_u32 v44, 0x10000, v36
    v_xor_b32 v37, 160, v70
    v_add_u32 v45, 0x10000, v37
    v_xor_b32 v38, 192, v70
    v_add_u32 v46, 0x10000, v38
    v_xor_b32 v39, 224, v70
    v_add_u32 v47, 0x10000, v39
    s_lshl_b32 s64, s64, 8
    s_add_u32 s64, s64, s65
    s_add_u32 s64, s64, 131072
    v_lshl_add_u32 v6, v64, 4, s64
    v_and_b32 v71, 1, v65
    v_lshl_add_u32 v6, v71, 9, v6
    v_lshrrev_b32 v71, 1, v65
    v_lshl_add_u32 v6, v71, 3, v6
    v_lshrrev_b32 v71, 5, v1
    v_bfe_u32 v72, v1, 4, 1
    v_lshlrev_b32 v72, 5, v72
    v_lshl_add_u32 v72, v67, 8, v72
    v_lshl_add_u32 v72, v69, 3, v72
    v_lshl_add_u32 v72, v71, 10, v72
    v_add_u32 v72, s65, v72
    s_and_b32 s64, s68, 1
    s_lshl_b32 s64, s64, 1
    v_xor_b32 v71, s64, v67
    v_lshl_add_u32 v16, v71, 6, v72
    v_xor_b32 v19, 64, v16
    v_add_u32 v17, 0x10000, v16
    v_add_u32 v18, 0x20000, v16
    v_add_u32 v20, 0x10000, v19
    v_add_u32 v21, 0x20000, v19
    v_mov_b32 v48, 0x3f803f80
    v_mov_b32 v49, 0x3f803f80
    v_mov_b32 v50, 0x3f803f80
    v_mov_b32 v51, 0x3f803f80
    v_and_b32 v4, 7, v1
    v_lshlrev_b32 v4, 4, v4
    v_lshrrev_b32 v71, 5, v1
    v_lshl_add_u32 v4, v71, 7, v4
    v_bfe_u32 v71, v1, 3, 2
    v_mul_u32_u24 v71, 32768, v71
    v_add_u32 v4, v71, v4
    v_mul_u32_u24 v60, 256, v1
    v_mov_b32 v61, 1
    s_mul_i32 s64, s53, 524288
    s_mul_i32 s72, s68, 131072
    s_add_u32 s72, s72, s64
    s_mul_i32 s65, s56, 1024
    s_add_u32 s72, s72, s65
    s_mul_i32 s74, s68, 1024
    s_mul_i32 s64, s53, 4096
    s_add_u32 s74, s74, s64
    s_lshl_b32 s65, s56, 2
    s_add_u32 s74, s74, s65
    s_add_u32 s74, s74, 16777216
    s_waitcnt lgkmcnt(0)
    s_mov_b32 s40, s14
    s_and_b32 s41, s15, 0xffff
    s_mov_b32 s44, s16
    s_and_b32 s45, s17, 0xffff
    s_mov_b32 s48, s18
    s_and_b32 s49, s19, 0xffff
    s_or_b32 s64, s56, s68
    s_cmp_lg_u32 s64, 0
    s_cbranch_scc1 L_noclr
    v_mov_b32 v52, 0
    v_mov_b32 v53, 0
    v_mov_b32 v54, 0
    v_mov_b32 v55, 0
    s_mul_i32 s64, s53, 4096
    s_add_u32 s64, s64, 16777216
    v_lshrrev_b32 v64, 3, v1
    v_mul_u32_u24 v64, 256, v64
    v_and_b32 v65, 7, v1
    v_lshl_add_u32 v64, v65, 4, v64
    s_add_u32 s65, s64, 0
    buffer_store_dwordx4 v[52:55], v64, s[48:51], s65 offen sc1
    s_add_u32 s65, s64, 2048
    buffer_store_dwordx4 v[52:55], v64, s[48:51], s65 offen sc1
    s_add_u32 s65, s64, 128
    buffer_store_dwordx4 v[52:55], v64, s[48:51], s65 offen sc1
    s_add_u32 s65, s64, 2176
    buffer_store_dwordx4 v[52:55], v64, s[48:51], s65 offen sc1
L_noclr:
    s_cmp_lg_u32 s68, 0
    s_cbranch_scc1 L_pcD0
    s_call_b64 s[78:79], L_pad0
L_pcD0:
    s_cmp_lg_u32 s68, 1
    s_cbranch_scc1 L_pcD1
    s_call_b64 s[78:79], L_pad4
L_pcD1:
    s_cmp_lg_u32 s68, 2
    s_cbranch_scc1 L_pcD2
    s_nop 0
L_pcD2:
    s_waitcnt lgkmcnt(0)
    s_barrier
    ds_read_b128 v[192:195], v26 offset:0
    ds_read_b64_tr_b16 v[64:65], v32 offset:0
    ds_read_b64_tr_b16 v[66:67], v32 offset:1024
    ds_read_b64_tr_b16 v[68:69], v33 offset:0
    ds_read_b64_tr_b16 v[70:71], v33 offset:1024
    ds_read_b64_tr_b16 v[72:73], v34 offset:0
    ds_read_b64_tr_b16 v[74:75], v34 offset:1024
    ds_read_b64_tr_b16 v[76:77], v35 offset:0
    ds_read_b64_tr_b16 v[78:79], v35 offset:1024
    ds_read_b64_tr_b16 v[80:81], v36 offset:0
    ds_read_b64_tr_b16 v[82:83], v36 offset:1024
    ds_read_b64_tr_b16 v[84:85], v37 offset:0
    ds_read_b64_tr_b16 v[86:87], v37 offset:1024
    ds_read_b64_tr_b16 v[88:89], v38 offset:0
    ds_read_b64_tr_b16 v[90:91], v38 offset:1024
    ds_read_b64_tr_b16 v[92:93], v39 offset:0
    ds_read_b64_tr_b16 v[94:95], v39 offset:1024
    s_waitcnt lgkmcnt(14)
    v_mfma_f32_16x16x32_bf16 v[128:131], v[64:67], v[192:195], 0
    ds_read_b128 v[196:199], v27 offset:0
    ds_read_b64_tr_b16 v[96:97], v32 offset:16384
    ds_read_b64_tr_b16 v[98:99], v32 offset:17408
    s_waitcnt lgkmcnt(9)
    v_mfma_f32_16x16x32_bf16 v[132:135], v[68:71], v[192:195], 0
    ds_read_b64_tr_b16 v[100:101], v33 offset:16384
    ds_read_b64_tr_b16 v[102:103], v33 offset:17408
    v_mfma_f32_16x16x32_bf16 v[136:139], v[72:75], v[192:195], 0
    ds_read_b64_tr_b16 v[104:105], v34 offset:16384
    ds_read_b64_tr_b16 v[106:107], v34 offset:17408
    v_mfma_f32_16x16x32_bf16 v[140:143], v[76:79], v[192:195], 0
    ds_read_b64_tr_b16 v[108:109], v35 offset:16384
    ds_read_b64_tr_b16 v[110:111], v35 offset:17408
    v_mfma_f32_16x16x32_bf16 v[144:147], v[80:83], v[192:195], 0
    ds_read_b64_tr_b16 v[112:113], v36 offset:16384
    ds_read_b64_tr_b16 v[114:115], v36 offset:17408
    s_waitcnt lgkmcnt(8)
    v_mfma_f32_16x16x32_bf16 v[148:151], v[84:87], v[192:195], 0
    ds_read_b64_tr_b16 v[116:117], v37 offset:16384
    ds_read_b64_tr_b16 v[118:119], v37 offset:17408
    v_mfma_f32_16x16x32_bf16 v[152:155], v[88:91], v[192:195], 0
    ds_read_b64_tr_b16 v[120:121], v38 offset:16384
    ds_read_b64_tr_b16 v[122:123], v38 offset:17408
    v_mfma_f32_16x16x32_bf16 v[156:159], v[92:95], v[192:195], 0
    ds_read_b64_tr_b16 v[124:125], v39 offset:16384
    ds_read_b64_tr_b16 v[126:127], v39 offset:17408
    v_mfma_f32_16x16x32_bf16 v[128:131], v[96:99], v[196:199], v[128:131]
    s_waitcnt lgkmcnt(6)
    v_mfma_f32_16x16x32_bf16 v[132:135], v[100:103], v[196:199], v[132:135]
    v_mfma_f32_16x16x32_bf16 v[136:139], v[104:107], v[196:199], v[136:139]
    v_mfma_f32_16x16x32_bf16 v[140:143], v[108:111], v[196:199], v[140:143]
    v_mfma_f32_16x16x32_bf16 v[144:147], v[112:115], v[196:199], v[144:147]
    s_waitcnt lgkmcnt(0)
    v_mfma_f32_16x16x32_bf16 v[148:151], v[116:119], v[196:199], v[148:151]
    v_mfma_f32_16x16x32_bf16 v[152:155], v[120:123], v[196:199], v[152:155]
    v_mfma_f32_16x16x32_bf16 v[156:159], v[124:127], v[196:199], v[156:159]
    s_waitcnt lgkmcnt(0)
    s_barrier
    ds_read_b128 v[200:203], v28 offset:0
    ds_read_b64_tr_b16 v[64:65], v32 offset:32768
    ds_read_b64_tr_b16 v[66:67], v32 offset:33792
    ds_read_b64_tr_b16 v[68:69], v33 offset:32768
    ds_read_b64_tr_b16 v[70:71], v33 offset:33792
    ds_read_b64_tr_b16 v[72:73], v34 offset:32768
    ds_read_b64_tr_b16 v[74:75], v34 offset:33792
    ds_read_b64_tr_b16 v[76:77], v35 offset:32768
    ds_read_b64_tr_b16 v[78:79], v35 offset:33792
    ds_read_b64_tr_b16 v[80:81], v36 offset:32768
    ds_read_b64_tr_b16 v[82:83], v36 offset:33792
    ds_read_b64_tr_b16 v[84:85], v37 offset:32768
    ds_read_b64_tr_b16 v[86:87], v37 offset:33792
    ds_read_b64_tr_b16 v[88:89], v38 offset:32768
    ds_read_b64_tr_b16 v[90:91], v38 offset:33792
    ds_read_b64_tr_b16 v[92:93], v39 offset:32768
    ds_read_b64_tr_b16 v[94:95], v39 offset:33792
    s_waitcnt lgkmcnt(14)
    v_mfma_f32_16x16x32_bf16 v[128:131], v[64:67], v[200:203], v[128:131]
    ds_read_b128 v[204:207], v29 offset:0
    ds_read_b64_tr_b16 v[96:97], v32 offset:49152
    ds_read_b64_tr_b16 v[98:99], v32 offset:50176
    s_waitcnt lgkmcnt(9)
    v_mfma_f32_16x16x32_bf16 v[132:135], v[68:71], v[200:203], v[132:135]
    ds_read_b64_tr_b16 v[100:101], v33 offset:49152
    ds_read_b64_tr_b16 v[102:103], v33 offset:50176
    v_mfma_f32_16x16x32_bf16 v[136:139], v[72:75], v[200:203], v[136:139]
    ds_read_b64_tr_b16 v[104:105], v34 offset:49152
    ds_read_b64_tr_b16 v[106:107], v34 offset:50176
    v_mfma_f32_16x16x32_bf16 v[140:143], v[76:79], v[200:203], v[140:143]
    ds_read_b64_tr_b16 v[108:109], v35 offset:49152
    ds_read_b64_tr_b16 v[110:111], v35 offset:50176
    v_mfma_f32_16x16x32_bf16 v[144:147], v[80:83], v[200:203], v[144:147]
    ds_read_b64_tr_b16 v[112:113], v36 offset:49152
    ds_read_b64_tr_b16 v[114:115], v36 offset:50176
    s_waitcnt lgkmcnt(8)
    v_mfma_f32_16x16x32_bf16 v[148:151], v[84:87], v[200:203], v[148:151]
    ds_read_b64_tr_b16 v[116:117], v37 offset:49152
    ds_read_b64_tr_b16 v[118:119], v37 offset:50176
    v_mfma_f32_16x16x32_bf16 v[152:155], v[88:91], v[200:203], v[152:155]
    ds_read_b64_tr_b16 v[120:121], v38 offset:49152
    ds_read_b64_tr_b16 v[122:123], v38 offset:50176
    v_mfma_f32_16x16x32_bf16 v[156:159], v[92:95], v[200:203], v[156:159]
    ds_read_b64_tr_b16 v[124:125], v39 offset:49152
    ds_read_b64_tr_b16 v[126:127], v39 offset:50176
    v_mfma_f32_16x16x32_bf16 v[128:131], v[96:99], v[204:207], v[128:131]
    s_waitcnt lgkmcnt(6)
    v_mfma_f32_16x16x32_bf16 v[132:135], v[100:103], v[204:207], v[132:135]
    v_mfma_f32_16x16x32_bf16 v[136:139], v[104:107], v[204:207], v[136:139]
    v_mfma_f32_16x16x32_bf16 v[140:143], v[108:111], v[204:207], v[140:143]
    v_mfma_f32_16x16x32_bf16 v[144:147], v[112:115], v[204:207], v[144:147]
    s_waitcnt lgkmcnt(0)
    v_mfma_f32_16x16x32_bf16 v[148:151], v[116:119], v[204:207], v[148:151]
    v_mfma_f32_16x16x32_bf16 v[152:155], v[120:123], v[204:207], v[152:155]
    v_mfma_f32_16x16x32_bf16 v[156:159], v[124:127], v[204:207], v[156:159]
    s_waitcnt lgkmcnt(0)
    s_barrier
    ds_read_b128 v[192:195], v26 offset:8192
    ds_read_b64_tr_b16 v[64:65], v40 offset:0
    ds_read_b64_tr_b16 v[66:67], v40 offset:1024
    ds_read_b64_tr_b16 v[68:69], v41 offset:0
    ds_read_b64_tr_b16 v[70:71], v41 offset:1024
    ds_read_b64_tr_b16 v[72:73], v42 offset:0
    ds_read_b64_tr_b16 v[74:75], v42 offset:1024
    ds_read_b64_tr_b16 v[76:77], v43 offset:0
    ds_read_b64_tr_b16 v[78:79], v43 offset:1024
    ds_read_b64_tr_b16 v[80:81], v44 offset:0
    ds_read_b64_tr_b16 v[82:83], v44 offset:1024
    ds_read_b64_tr_b16 v[84:85], v45 offset:0
    ds_read_b64_tr_b16 v[86:87], v45 offset:1024
    ds_read_b64_tr_b16 v[88:89], v46 offset:0
    ds_read_b64_tr_b16 v[90:91], v46 offset:1024
    ds_read_b64_tr_b16 v[92:93], v47 offset:0
    ds_read_b64_tr_b16 v[94:95], v47 offset:1024
    s_waitcnt lgkmcnt(14)
    v_mfma_f32_16x16x32_bf16 v[128:131], v[64:67], v[192:195], v[128:131]
    ds_read_b128 v[196:199], v27 offset:8192
    ds_read_b64_tr_b16 v[96:97], v40 offset:16384
    ds_read_b64_tr_b16 v[98:99], v40 offset:17408
    s_waitcnt lgkmcnt(9)
    v_mfma_f32_16x16x32_bf16 v[132:135], v[68:71], v[192:195], v[132:135]
    ds_read_b64_tr_b16 v[100:101], v41 offset:16384
    ds_read_b64_tr_b16 v[102:103], v41 offset:17408
    v_mfma_f32_16x16x32_bf16 v[136:139], v[72:75], v[192:195], v[136:139]
    ds_read_b64_tr_b16 v[104:105], v42 offset:16384
    ds_read_b64_tr_b16 v[106:107], v42 offset:17408
    v_mfma_f32_16x16x32_bf16 v[140:143], v[76:79], v[192:195], v[140:143]
    ds_read_b64_tr_b16 v[108:109], v43 offset:16384
    ds_read_b64_tr_b16 v[110:111], v43 offset:17408
    v_mfma_f32_16x16x32_bf16 v[144:147], v[80:83], v[192:195], v[144:147]
    ds_read_b64_tr_b16 v[112:113], v44 offset:16384
    ds_read_b64_tr_b16 v[114:115], v44 offset:17408
    s_waitcnt lgkmcnt(8)
    v_mfma_f32_16x16x32_bf16 v[148:151], v[84:87], v[192:195], v[148:151]
    ds_read_b64_tr_b16 v[116:117], v45 offset:16384
    ds_read_b64_tr_b16 v[118:119], v45 offset:17408
    v_mfma_f32_16x16x32_bf16 v[152:155], v[88:91], v[192:195], v[152:155]
    ds_read_b64_tr_b16 v[120:121], v46 offset:16384
    ds_read_b64_tr_b16 v[122:123], v46 offset:17408
    v_mfma_f32_16x16x32_bf16 v[156:159], v[92:95], v[192:195], v[156:159]
    ds_read_b64_tr_b16 v[124:125], v47 offset:16384
    ds_read_b64_tr_b16 v[126:127], v47 offset:17408
    v_mfma_f32_16x16x32_bf16 v[128:131], v[96:99], v[196:199], v[128:131]
    s_waitcnt lgkmcnt(6)
    v_mfma_f32_16x16x32_bf16 v[132:135], v[100:103], v[196:199], v[132:135]
    v_mfma_f32_16x16x32_bf16 v[136:139], v[104:107], v[196:199], v[136:139]
    v_mfma_f32_16x16x32_bf16 v[140:143], v[108:111], v[196:199], v[140:143]
    v_mfma_f32_16x16x32_bf16 v[144:147], v[112:115], v[196:199], v[144:147]
    s_waitcnt lgkmcnt(0)
    v_mfma_f32_16x16x32_bf16 v[148:151], v[116:119], v[196:199], v[148:151]
    v_mfma_f32_16x16x32_bf16 v[152:155], v[120:123], v[196:199], v[152:155]
    v_mfma_f32_16x16x32_bf16 v[156:159], v[124:127], v[196:199], v[156:159]
    s_waitcnt lgkmcnt(0)
    s_barrier
    ds_read_b128 v[200:203], v28 offset:8192
    ds_read_b64_tr_b16 v[64:65], v40 offset:32768
    ds_read_b64_tr_b16 v[66:67], v40 offset:33792
    ds_read_b64_tr_b16 v[68:69], v41 offset:32768
    ds_read_b64_tr_b16 v[70:71], v41 offset:33792
    ds_read_b64_tr_b16 v[72:73], v42 offset:32768
    ds_read_b64_tr_b16 v[74:75], v42 offset:33792
    ds_read_b64_tr_b16 v[76:77], v43 offset:32768
    ds_read_b64_tr_b16 v[78:79], v43 offset:33792
    ds_read_b64_tr_b16 v[80:81], v44 offset:32768
    ds_read_b64_tr_b16 v[82:83], v44 offset:33792
    ds_read_b64_tr_b16 v[84:85], v45 offset:32768
    ds_read_b64_tr_b16 v[86:87], v45 offset:33792
    ds_read_b64_tr_b16 v[88:89], v46 offset:32768
    ds_read_b64_tr_b16 v[90:91], v46 offset:33792
    ds_read_b64_tr_b16 v[92:93], v47 offset:32768
    ds_read_b64_tr_b16 v[94:95], v47 offset:33792
    s_waitcnt lgkmcnt(14)
    v_mfma_f32_16x16x32_bf16 v[128:131], v[64:67], v[200:203], v[128:131]
    ds_read_b128 v[204:207], v29 offset:8192
    ds_read_b64_tr_b16 v[96:97], v40 offset:49152
    ds_read_b64_tr_b16 v[98:99], v40 offset:50176
    s_waitcnt lgkmcnt(9)
    v_mfma_f32_16x16x32_bf16 v[132:135], v[68:71], v[200:203], v[132:135]
    ds_read_b64_tr_b16 v[100:101], v41 offset:49152
    ds_read_b64_tr_b16 v[102:103], v41 offset:50176
    v_mfma_f32_16x16x32_bf16 v[136:139], v[72:75], v[200:203], v[136:139]
    ds_read_b64_tr_b16 v[104:105], v42 offset:49152
    ds_read_b64_tr_b16 v[106:107], v42 offset:50176
    v_mfma_f32_16x16x32_bf16 v[140:143], v[76:79], v[200:203], v[140:143]
    ds_read_b64_tr_b16 v[108:109], v43 offset:49152
    ds_read_b64_tr_b16 v[110:111], v43 offset:50176
    v_mfma_f32_16x16x32_bf16 v[144:147], v[80:83], v[200:203], v[144:147]
    ds_read_b64_tr_b16 v[112:113], v44 offset:49152
    ds_read_b64_tr_b16 v[114:115], v44 offset:50176
    s_waitcnt lgkmcnt(8)
    v_mfma_f32_16x16x32_bf16 v[148:151], v[84:87], v[200:203], v[148:151]
    ds_read_b64_tr_b16 v[116:117], v45 offset:49152
    ds_read_b64_tr_b16 v[118:119], v45 offset:50176
    v_mfma_f32_16x16x32_bf16 v[152:155], v[88:91], v[200:203], v[152:155]
    ds_read_b64_tr_b16 v[120:121], v46 offset:49152
    ds_read_b64_tr_b16 v[122:123], v46 offset:50176
    v_mfma_f32_16x16x32_bf16 v[156:159], v[92:95], v[200:203], v[156:159]
    ds_read_b64_tr_b16 v[124:125], v47 offset:49152
    ds_read_b64_tr_b16 v[126:127], v47 offset:50176
    v_mfma_f32_16x16x32_bf16 v[128:131], v[96:99], v[204:207], v[128:131]
    s_waitcnt lgkmcnt(6)
    v_mfma_f32_16x16x32_bf16 v[132:135], v[100:103], v[204:207], v[132:135]
    v_mfma_f32_16x16x32_bf16 v[136:139], v[104:107], v[204:207], v[136:139]
    v_mfma_f32_16x16x32_bf16 v[140:143], v[108:111], v[204:207], v[140:143]
    v_mfma_f32_16x16x32_bf16 v[144:147], v[112:115], v[204:207], v[144:147]
    s_waitcnt lgkmcnt(0)
    v_mfma_f32_16x16x32_bf16 v[148:151], v[116:119], v[204:207], v[148:151]
    v_mfma_f32_16x16x32_bf16 v[152:155], v[120:123], v[204:207], v[152:155]
    v_mfma_f32_16x16x32_bf16 v[156:159], v[124:127], v[204:207], v[156:159]
    s_waitcnt lgkmcnt(0)
    s_barrier
    ds_read_b128 v[192:195], v26 offset:16384
    ds_read_b64_tr_b16 v[64:65], v32 offset:0
    ds_read_b64_tr_b16 v[66:67], v32 offset:1024
    ds_read_b64_tr_b16 v[68:69], v33 offset:0
    ds_read_b64_tr_b16 v[70:71], v33 offset:1024
    ds_read_b64_tr_b16 v[72:73], v34 offset:0
    ds_read_b64_tr_b16 v[74:75], v34 offset:1024
    ds_read_b64_tr_b16 v[76:77], v35 offset:0
    ds_read_b64_tr_b16 v[78:79], v35 offset:1024
    ds_read_b64_tr_b16 v[80:81], v36 offset:0
    ds_read_b64_tr_b16 v[82:83], v36 offset:1024
    ds_read_b64_tr_b16 v[84:85], v37 offset:0
    ds_read_b64_tr_b16 v[86:87], v37 offset:1024
    ds_read_b64_tr_b16 v[88:89], v38 offset:0
    ds_read_b64_tr_b16 v[90:91], v38 offset:1024
    ds_read_b64_tr_b16 v[92:93], v39 offset:0
    ds_read_b64_tr_b16 v[94:95], v39 offset:1024
    s_waitcnt lgkmcnt(14)
    v_mfma_f32_16x16x32_bf16 v[128:131], v[64:67], v[192:195], v[128:131]
    ds_read_b128 v[196:199], v27 offset:16384
    ds_read_b64_tr_b16 v[96:97], v32 offset:16384
    ds_read_b64_tr_b16 v[98:99], v32 offset:17408
    s_waitcnt lgkmcnt(9)
    v_mfma_f32_16x16x32_bf16 v[132:135], v[68:71], v[192:195], v[132:135]
    ds_read_b64_tr_b16 v[100:101], v33 offset:16384
    ds_read_b64_tr_b16 v[102:103], v33 offset:17408
    v_mfma_f32_16x16x32_bf16 v[136:139], v[72:75], v[192:195], v[136:139]
    ds_read_b64_tr_b16 v[104:105], v34 offset:16384
    ds_read_b64_tr_b16 v[106:107], v34 offset:17408
    v_mfma_f32_16x16x32_bf16 v[140:143], v[76:79], v[192:195], v[140:143]
    ds_read_b64_tr_b16 v[108:109], v35 offset:16384
    ds_read_b64_tr_b16 v[110:111], v35 offset:17408
    v_mfma_f32_16x16x32_bf16 v[144:147], v[80:83], v[192:195], v[144:147]
    ds_read_b64_tr_b16 v[112:113], v36 offset:16384
    ds_read_b64_tr_b16 v[114:115], v36 offset:17408
    s_waitcnt lgkmcnt(8)
    v_mfma_f32_16x16x32_bf16 v[148:151], v[84:87], v[192:195], v[148:151]
    ds_read_b64_tr_b16 v[116:117], v37 offset:16384
    ds_read_b64_tr_b16 v[118:119], v37 offset:17408
    v_mfma_f32_16x16x32_bf16 v[152:155], v[88:91], v[192:195], v[152:155]
    ds_read_b64_tr_b16 v[120:121], v38 offset:16384
    ds_read_b64_tr_b16 v[122:123], v38 offset:17408
    v_mfma_f32_16x16x32_bf16 v[156:159], v[92:95], v[192:195], v[156:159]
    ds_read_b64_tr_b16 v[124:125], v39 offset:16384
    ds_read_b64_tr_b16 v[126:127], v39 offset:17408
    v_mfma_f32_16x16x32_bf16 v[128:131], v[96:99], v[196:199], v[128:131]
    s_waitcnt lgkmcnt(6)
    v_mfma_f32_16x16x32_bf16 v[132:135], v[100:103], v[196:199], v[132:135]
    v_mfma_f32_16x16x32_bf16 v[136:139], v[104:107], v[196:199], v[136:139]
    v_mfma_f32_16x16x32_bf16 v[140:143], v[108:111], v[196:199], v[140:143]
    v_mfma_f32_16x16x32_bf16 v[144:147], v[112:115], v[196:199], v[144:147]
    s_waitcnt lgkmcnt(0)
    v_mfma_f32_16x16x32_bf16 v[148:151], v[116:119], v[196:199], v[148:151]
    v_mfma_f32_16x16x32_bf16 v[152:155], v[120:123], v[196:199], v[152:155]
    v_mfma_f32_16x16x32_bf16 v[156:159], v[124:127], v[196:199], v[156:159]
    s_waitcnt lgkmcnt(0)
    s_barrier
    ds_read_b128 v[200:203], v28 offset:16384
    ds_read_b64_tr_b16 v[64:65], v32 offset:32768
    ds_read_b64_tr_b16 v[66:67], v32 offset:33792
    ds_read_b64_tr_b16 v[68:69], v33 offset:32768
    ds_read_b64_tr_b16 v[70:71], v33 offset:33792
    ds_read_b64_tr_b16 v[72:73], v34 offset:32768
    ds_read_b64_tr_b16 v[74:75], v34 offset:33792
    ds_read_b64_tr_b16 v[76:77], v35 offset:32768
    ds_read_b64_tr_b16 v[78:79], v35 offset:33792
    ds_read_b64_tr_b16 v[80:81], v36 offset:32768
    ds_read_b64_tr_b16 v[82:83], v36 offset:33792
    ds_read_b64_tr_b16 v[84:85], v37 offset:32768
    ds_read_b64_tr_b16 v[86:87], v37 offset:33792
    ds_read_b64_tr_b16 v[88:89], v38 offset:32768
    ds_read_b64_tr_b16 v[90:91], v38 offset:33792
    ds_read_b64_tr_b16 v[92:93], v39 offset:32768
    ds_read_b64_tr_b16 v[94:95], v39 offset:33792
    s_waitcnt lgkmcnt(14)
    v_mfma_f32_16x16x32_bf16 v[128:131], v[64:67], v[200:203], v[128:131]
    ds_read_b128 v[204:207], v29 offset:16384
    ds_read_b64_tr_b16 v[96:97], v32 offset:49152
    ds_read_b64_tr_b16 v[98:99], v32 offset:50176
    s_waitcnt lgkmcnt(9)
    v_mfma_f32_16x16x32_bf16 v[132:135], v[68:71], v[200:203], v[132:135]
    ds_read_b64_tr_b16 v[100:101], v33 offset:49152
    ds_read_b64_tr_b16 v[102:103], v33 offset:50176
    v_mfma_f32_16x16x32_bf16 v[136:139], v[72:75], v[200:203], v[136:139]
    ds_read_b64_tr_b16 v[104:105], v34 offset:49152
    ds_read_b64_tr_b16 v[106:107], v34 offset:50176
    v_mfma_f32_16x16x32_bf16 v[140:143], v[76:79], v[200:203], v[140:143]
    ds_read_b64_tr_b16 v[108:109], v35 offset:49152
    ds_read_b64_tr_b16 v[110:111], v35 offset:50176
    v_mfma_f32_16x16x32_bf16 v[144:147], v[80:83], v[200:203], v[144:147]
    ds_read_b64_tr_b16 v[112:113], v36 offset:49152
    ds_read_b64_tr_b16 v[114:115], v36 offset:50176
    s_waitcnt lgkmcnt(8)
    v_mfma_f32_16x16x32_bf16 v[148:151], v[84:87], v[200:203], v[148:151]
    ds_read_b64_tr_b16 v[116:117], v37 offset:49152
    ds_read_b64_tr_b16 v[118:119], v37 offset:50176
    v_mfma_f32_16x16x32_bf16 v[152:155], v[88:91], v[200:203], v[152:155]
    ds_read_b64_tr_b16 v[120:121], v38 offset:49152
    ds_read_b64_tr_b16 v[122:123], v38 offset:50176
    v_mfma_f32_16x16x32_bf16 v[156:159], v[92:95], v[200:203], v[156:159]
    ds_read_b64_tr_b16 v[124:125], v39 offset:49152
    ds_read_b64_tr_b16 v[126:127], v39 offset:50176
    v_mfma_f32_16x16x32_bf16 v[128:131], v[96:99], v[204:207], v[128:131]
    s_waitcnt lgkmcnt(6)
    v_mfma_f32_16x16x32_bf16 v[132:135], v[100:103], v[204:207], v[132:135]
    v_mfma_f32_16x16x32_bf16 v[136:139], v[104:107], v[204:207], v[136:139]
    v_mfma_f32_16x16x32_bf16 v[140:143], v[108:111], v[204:207], v[140:143]
    v_mfma_f32_16x16x32_bf16 v[144:147], v[112:115], v[204:207], v[144:147]
    s_waitcnt lgkmcnt(0)
    v_mfma_f32_16x16x32_bf16 v[148:151], v[116:119], v[204:207], v[148:151]
    v_mfma_f32_16x16x32_bf16 v[152:155], v[120:123], v[204:207], v[152:155]
    v_mfma_f32_16x16x32_bf16 v[156:159], v[124:127], v[204:207], v[156:159]
    s_waitcnt lgkmcnt(0)
    s_barrier
    ds_read_b128 v[192:195], v26 offset:24576
    ds_read_b64_tr_b16 v[64:65], v40 offset:0
    s_branch L_pad1x
.p2align 12
L_pad1:
    s_setpc_b64 s[78:79]
    s_nop 0
L_pad1x:
    ds_read_b64_tr_b16 v[66:67], v40 offset:1024
    ds_read_b64_tr_b16 v[68:69], v41 offset:0
    ds_read_b64_tr_b16 v[70:71], v41 offset:1024
    ds_read_b64_tr_b16 v[72:73], v42 offset:0
    ds_read_b64_tr_b16 v[74:75], v42 offset:1024
    ds_read_b64_tr_b16 v[76:77], v43 offset:0
    ds_read_b64_tr_b16 v[78:79], v43 offset:1024
    ds_read_b64_tr_b16 v[80:81], v44 offset:0
    ds_read_b64_tr_b16 v[82:83], v44 offset:1024
    ds_read_b64_tr_b16 v[84:85], v45 offset:0
    ds_read_b64_tr_b16 v[86:87], v45 offset:1024
    ds_read_b64_tr_b16 v[88:89], v46 offset:0
    ds_read_b64_tr_b16 v[90:91], v46 offset:1024
    ds_read_b64_tr_b16 v[92:93], v47 offset:0
    ds_read_b64_tr_b16 v[94:95], v47 offset:1024
    s_waitcnt lgkmcnt(14)
    v_mfma_f32_16x16x32_bf16 v[128:131], v[64:67], v[192:195], v[128:131]
    ds_read_b128 v[196:199], v27 offset:24576
    ds_read_b64_tr_b16 v[96:97], v40 offset:16384
    ds_read_b64_tr_b16 v[98:99], v40 offset:17408
    s_waitcnt lgkmcnt(9)
    v_mfma_f32_16x16x32_bf16 v[132:135], v[68:71], v[192:195], v[132:135]
    ds_read_b64_tr_b16 v[100:101], v41 offset:16384
    ds_read_b64_tr_b16 v[102:103], v41 offset:17408
    v_mfma_f32_16x16x32_bf16 v[136:139], v[72:75], v[192:195], v[136:139]
    ds_read_b64_tr_b16 v[104:105], v42 offset:16384
    ds_read_b64_tr_b16 v[106:107], v42 offset:17408
    v_mfma_f32_16x16x32_bf16 v[140:143], v[76:79], v[192:195], v[140:143]
    ds_read_b64_tr_b16 v[108:109], v43 offset:16384
    ds_read_b64_tr_b16 v[110:111], v43 offset:17408
    v_mfma_f32_16x16x32_bf16 v[144:147], v[80:83], v[192:195], v[144:147]
    ds_read_b64_tr_b16 v[112:113], v44 offset:16384
    ds_read_b64_tr_b16 v[114:115], v44 offset:17408
    s_waitcnt lgkmcnt(8)
    v_mfma_f32_16x16x32_bf16 v[148:151], v[84:87], v[192:195], v[148:151]
    ds_read_b64_tr_b16 v[116:117], v45 offset:16384
    ds_read_b64_tr_b16 v[118:119], v45 offset:17408
    v_mfma_f32_16x16x32_bf16 v[152:155], v[88:91], v[192:195], v[152:155]
    ds_read_b64_tr_b16 v[120:121], v46 offset:16384
    ds_read_b64_tr_b16 v[122:123], v46 offset:17408
    v_mfma_f32_16x16x32_bf16 v[156:159], v[92:95], v[192:195], v[156:159]
    ds_read_b64_tr_b16 v[124:125], v47 offset:16384
    ds_read_b64_tr_b16 v[126:127], v47 offset:17408
    v_mfma_f32_16x16x32_bf16 v[128:131], v[96:99], v[196:199], v[128:131]
    s_waitcnt lgkmcnt(6)
    v_mfma_f32_16x16x32_bf16 v[132:135], v[100:103], v[196:199], v[132:135]
    v_mfma_f32_16x16x32_bf16 v[136:139], v[104:107], v[196:199], v[136:139]
    v_mfma_f32_16x16x32_bf16 v[140:143], v[108:111], v[196:199], v[140:143]
    v_mfma_f32_16x16x32_bf16 v[144:147], v[112:115], v[196:199], v[144:147]
    s_waitcnt lgkmcnt(0)
    v_mfma_f32_16x16x32_bf16 v[148:151], v[116:119], v[196:199], v[148:151]
    v_mfma_f32_16x16x32_bf16 v[152:155], v[120:123], v[196:199], v[152:155]
    v_mfma_f32_16x16x32_bf16 v[156:159], v[124:127], v[196:199], v[156:159]
    s_waitcnt lgkmcnt(0)
    s_barrier
    ds_read_b128 v[200:203], v28 offset:24576
    ds_read_b64_tr_b16 v[64:65], v40 offset:32768
    ds_read_b64_tr_b16 v[66:67], v40 offset:33792
    ds_read_b64_tr_b16 v[68:69], v41 offset:32768
    ds_read_b64_tr_b16 v[70:71], v41 offset:33792
    ds_read_b64_tr_b16 v[72:73], v42 offset:32768
    ds_read_b64_tr_b16 v[74:75], v42 offset:33792
    ds_read_b64_tr_b16 v[76:77], v43 offset:32768
    ds_read_b64_tr_b16 v[78:79], v43 offset:33792
    ds_read_b64_tr_b16 v[80:81], v44 offset:32768
    ds_read_b64_tr_b16 v[82:83], v44 offset:33792
    ds_read_b64_tr_b16 v[84:85], v45 offset:32768
    ds_read_b64_tr_b16 v[86:87], v45 offset:33792
    ds_read_b64_tr_b16 v[88:89], v46 offset:32768
    ds_read_b64_tr_b16 v[90:91], v46 offset:33792
    ds_read_b64_tr_b16 v[92:93], v47 offset:32768
    ds_read_b64_tr_b16 v[94:95], v47 offset:33792
    s_waitcnt lgkmcnt(14)
    v_mfma_f32_16x16x32_bf16 v[128:131], v[64:67], v[200:203], v[128:131]
    ds_read_b128 v[204:207], v29 offset:24576
    ds_read_b64_tr_b16 v[96:97], v40 offset:49152
    ds_read_b64_tr_b16 v[98:99], v40 offset:50176
    s_waitcnt lgkmcnt(9)
    v_mfma_f32_16x16x32_bf16 v[132:135], v[68:71], v[200:203], v[132:135]
    ds_read_b64_tr_b16 v[100:101], v41 offset:49152
    ds_read_b64_tr_b16 v[102:103], v41 offset:50176
    v_mfma_f32_16x16x32_bf16 v[136:139], v[72:75], v[200:203], v[136:139]
    ds_read_b64_tr_b16 v[104:105], v42 offset:49152
    ds_read_b64_tr_b16 v[106:107], v42 offset:50176
    v_mfma_f32_16x16x32_bf16 v[140:143], v[76:79], v[200:203], v[140:143]
    ds_read_b64_tr_b16 v[108:109], v43 offset:49152
    ds_read_b64_tr_b16 v[110:111], v43 offset:50176
    v_mfma_f32_16x16x32_bf16 v[144:147], v[80:83], v[200:203], v[144:147]
    ds_read_b64_tr_b16 v[112:113], v44 offset:49152
    ds_read_b64_tr_b16 v[114:115], v44 offset:50176
    s_waitcnt lgkmcnt(8)
    v_mfma_f32_16x16x32_bf16 v[148:151], v[84:87], v[200:203], v[148:151]
    ds_read_b64_tr_b16 v[116:117], v45 offset:49152
    ds_read_b64_tr_b16 v[118:119], v45 offset:50176
    v_mfma_f32_16x16x32_bf16 v[152:155], v[88:91], v[200:203], v[152:155]
    ds_read_b64_tr_b16 v[120:121], v46 offset:49152
    ds_read_b64_tr_b16 v[122:123], v46 offset:50176
    v_mfma_f32_16x16x32_bf16 v[156:159], v[92:95], v[200:203], v[156:159]
    ds_read_b64_tr_b16 v[124:125], v47 offset:49152
    ds_read_b64_tr_b16 v[126:127], v47 offset:50176
    v_mfma_f32_16x16x32_bf16 v[128:131], v[96:99], v[204:207], v[128:131]
    s_waitcnt lgkmcnt(6)
    v_mfma_f32_16x16x32_bf16 v[132:135], v[100:103], v[204:207], v[132:135]
    v_mfma_f32_16x16x32_bf16 v[136:139], v[104:107], v[204:207], v[136:139]
    v_mfma_f32_16x16x32_bf16 v[140:143], v[108:111], v[204:207], v[140:143]
    v_mfma_f32_16x16x32_bf16 v[144:147], v[112:115], v[204:207], v[144:147]
    s_waitcnt lgkmcnt(0)
    v_mfma_f32_16x16x32_bf16 v[148:151], v[116:119], v[204:207], v[148:151]
    v_mfma_f32_16x16x32_bf16 v[152:155], v[120:123], v[204:207], v[152:155]
    v_mfma_f32_16x16x32_bf16 v[156:159], v[124:127], v[204:207], v[156:159]
    v_add_u32 v26, 0x10000, v22
    v_add_u32 v27, 0x10000, v23
    v_add_u32 v28, 0x10000, v24
    v_add_u32 v29, 0x10000, v25
    v_xor_b32 v32, 0, v62
    v_add_u32 v40, 0x10000, v32
    v_xor_b32 v33, 32, v62
    v_add_u32 v41, 0x10000, v33
    v_xor_b32 v34, 64, v62
    v_add_u32 v42, 0x10000, v34
    v_xor_b32 v35, 96, v62
    v_add_u32 v43, 0x10000, v35
    v_xor_b32 v36, 128, v62
    v_add_u32 v44, 0x10000, v36
    v_xor_b32 v37, 160, v62
    v_add_u32 v45, 0x10000, v37
    v_xor_b32 v38, 192, v62
    v_add_u32 v46, 0x10000, v38
    v_xor_b32 v39, 224, v62
    v_add_u32 v47, 0x10000, v39
    v_mul_f32 v128, s69, v128
    v_mul_f32 v129, s69, v129
    v_mul_f32 v130, s69, v130
    v_mul_f32 v131, s69, v131
    v_mul_f32 v132, s69, v132
    v_mul_f32 v133, s69, v133
    v_mul_f32 v134, s69, v134
    v_mul_f32 v135, s69, v135
    v_mul_f32 v136, s69, v136
    v_mul_f32 v137, s69, v137
    v_mul_f32 v138, s69, v138
    v_mul_f32 v139, s69, v139
    v_mul_f32 v140, s69, v140
    v_mul_f32 v141, s69, v141
    v_mul_f32 v142, s69, v142
    v_mul_f32 v143, s69, v143
    v_mul_f32 v144, s69, v144
    v_mul_f32 v145, s69, v145
    v_mul_f32 v146, s69, v146
    v_mul_f32 v147, s69, v147
    v_mul_f32 v148, s69, v148
    v_mul_f32 v149, s69, v149
    v_mul_f32 v150, s69, v150
    v_mul_f32 v151, s69, v151
    v_mul_f32 v152, s69, v152
    v_mul_f32 v153, s69, v153
    v_mul_f32 v154, s69, v154
    v_mul_f32 v155, s69, v155
    v_mul_f32 v156, s69, v156
    v_mul_f32 v157, s69, v157
    v_mul_f32 v158, s69, v158
    v_mul_f32 v159, s69, v159
    v_cvt_pk_bf16_f32 v240, v128, v129
    v_cvt_pk_bf16_f32 v241, v130, v131
    v_cvt_pk_bf16_f32 v242, v132, v133
    v_cvt_pk_bf16_f32 v243, v134, v135
    v_cvt_pk_bf16_f32 v244, v136, v137
    v_cvt_pk_bf16_f32 v245, v138, v139
    v_cvt_pk_bf16_f32 v246, v140, v141
    v_cvt_pk_bf16_f32 v247, v142, v143
    v_cvt_pk_bf16_f32 v248, v144, v145
    v_cvt_pk_bf16_f32 v249, v146, v147
    v_cvt_pk_bf16_f32 v250, v148, v149
    v_cvt_pk_bf16_f32 v251, v150, v151
    v_cvt_pk_bf16_f32 v252, v152, v153
    v_cvt_pk_bf16_f32 v253, v154, v155
    v_cvt_pk_bf16_f32 v254, v156, v157
    v_cvt_pk_bf16_f32 v255, v158, v159
    v_permlane32_swap_b32 v240, v242
    v_permlane32_swap_b32 v241, v243
    v_permlane32_swap_b32 v244, v246
    v_permlane32_swap_b32 v245, v247
    v_permlane32_swap_b32 v248, v250
    v_permlane32_swap_b32 v249, v251
    v_permlane32_swap_b32 v252, v254
    v_permlane32_swap_b32 v253, v255
    v_permlane16_swap_b32 v240, v242
    v_permlane16_swap_b32 v241, v243
    v_permlane16_swap_b32 v244, v246
    v_permlane16_swap_b32 v245, v247
    v_permlane16_swap_b32 v248, v250
    v_permlane16_swap_b32 v249, v251
    v_permlane16_swap_b32 v252, v254
    v_permlane16_swap_b32 v253, v255
    s_or_b32 s64, s56, s68
    s_cmp_lg_u32 s64, 0
    s_cbranch_scc1 L_nordy
    s_waitcnt vmcnt(0)
    v_mov_b32 v8, 0
    s_lshl_b32 s64, s53, 2
    s_mov_b64 exec, 1
    buffer_store_dword v61, v8, s[44:47], s64 offen offset:128 sc1
    s_mov_b64 exec, -1
L_nordy:
    s_mov_b32 s66, 0x41000000
    s_waitcnt lgkmcnt(0)
    s_barrier
    ds_read_b128 v[64:67], v22 offset:0
    ds_read_b128 v[68:71], v23 offset:0
    ds_read_b128 v[72:75], v24 offset:0
    ds_read_b128 v[76:79], v25 offset:0
    ds_read_b128 v[80:83], v22 offset:4096
    ds_read_b128 v[84:87], v23 offset:4096
    ds_read_b128 v[88:91], v24 offset:4096
    ds_read_b128 v[92:95], v25 offset:4096
    ds_read_b128 v[96:99], v22 offset:8192
    ds_read_b128 v[100:103], v23 offset:8192
    ds_read_b128 v[104:107], v24 offset:8192
    ds_read_b128 v[108:111], v25 offset:8192
    s_waitcnt lgkmcnt(11)
    v_mfma_f32_16x16x32_bf16 v[128:131], v[64:67], v[240:243], 0
    ds_read_b128 v[112:115], v22 offset:12288
    s_waitcnt lgkmcnt(8)
    v_mfma_f32_16x16x32_bf16 v[128:131], v[68:71], v[244:247], v[128:131]
    ds_read_b128 v[116:119], v23 offset:12288
    v_mfma_f32_16x16x32_bf16 v[128:131], v[72:75], v[248:251], v[128:131]
    ds_read_b128 v[120:123], v24 offset:12288
    v_mfma_f32_16x16x32_bf16 v[128:131], v[76:79], v[252:255], v[128:131]
    ds_read_b128 v[124:127], v25 offset:12288
    v_mfma_f32_16x16x32_bf16 v[132:135], v[80:83], v[240:243], 0
    ds_read_b128 v[64:67], v22 offset:16384
    s_waitcnt lgkmcnt(8)
    v_mfma_f32_16x16x32_bf16 v[132:135], v[84:87], v[244:247], v[132:135]
    ds_read_b128 v[68:71], v23 offset:16384
    v_mfma_f32_16x16x32_bf16 v[132:135], v[88:91], v[248:251], v[132:135]
    ds_read_b128 v[72:75], v24 offset:16384
    v_mfma_f32_16x16x32_bf16 v[132:135], v[92:95], v[252:255], v[132:135]
    ds_read_b128 v[76:79], v25 offset:16384
    v_mfma_f32_16x16x32_bf16 v[136:139], v[96:99], v[240:243], 0
    ds_read_b128 v[80:83], v22 offset:20480
    s_waitcnt lgkmcnt(8)
    v_mfma_f32_16x16x32_bf16 v[136:139], v[100:103], v[244:247], v[136:139]
    ds_read_b128 v[84:87], v23 offset:20480
    v_mfma_f32_16x16x32_bf16 v[136:139], v[104:107], v[248:251], v[136:139]
    ds_read_b128 v[88:91], v24 offset:20480
    v_mfma_f32_16x16x32_bf16 v[136:139], v[108:111], v[252:255], v[136:139]
    ds_read_b128 v[92:95], v25 offset:20480
    v_mfma_f32_16x16x32_bf16 v[140:143], v[112:115], v[240:243], 0
    ds_read_b128 v[96:99], v22 offset:24576
    s_waitcnt lgkmcnt(8)
    v_mfma_f32_16x16x32_bf16 v[140:143], v[116:119], v[244:247], v[140:143]
    ds_read_b128 v[100:103], v23 offset:24576
    v_mfma_f32_16x16x32_bf16 v[140:143], v[120:123], v[248:251], v[140:143]
    ds_read_b128 v[104:107], v24 offset:24576
    v_mfma_f32_16x16x32_bf16 v[140:143], v[124:127], v[252:255], v[140:143]
    ds_read_b128 v[108:111], v25 offset:24576
    v_mfma_f32_16x16x32_bf16 v[144:147], v[64:67], v[240:243], 0
    ds_read_b128 v[112:115], v22 offset:28672
    s_waitcnt lgkmcnt(8)
    v_mfma_f32_16x16x32_bf16 v[144:147], v[68:71], v[244:247], v[144:147]
    ds_read_b128 v[116:119], v23 offset:28672
    v_mfma_f32_16x16x32_bf16 v[144:147], v[72:75], v[248:251], v[144:147]
    ds_read_b128 v[120:123], v24 offset:28672
    v_mfma_f32_16x16x32_bf16 v[144:147], v[76:79], v[252:255], v[144:147]
    ds_read_b128 v[124:127], v25 offset:28672
    v_mfma_f32_16x16x32_bf16 v[148:151], v[80:83], v[240:243], 0
    s_waitcnt lgkmcnt(7)
    v_mfma_f32_16x16x32_bf16 v[148:151], v[84:87], v[244:247], v[148:151]
    v_mfma_f32_16x16x32_bf16 v[148:151], v[88:91], v[248:251], v[148:151]
    v_mfma_f32_16x16x32_bf16 v[148:151], v[92:95], v[252:255], v[148:151]
    v_mfma_f32_16x16x32_bf16 v[152:155], v[96:99], v[240:243], 0
    s_waitcnt lgkmcnt(3)
    v_mfma_f32_16x16x32_bf16 v[152:155], v[100:103], v[244:247], v[152:155]
    v_mfma_f32_16x16x32_bf16 v[152:155], v[104:107], v[248:251], v[152:155]
    v_mfma_f32_16x16x32_bf16 v[152:155], v[108:111], v[252:255], v[152:155]
    v_mfma_f32_16x16x32_bf16 v[156:159], v[112:115], v[240:243], 0
    s_waitcnt lgkmcnt(0)
    v_mfma_f32_16x16x32_bf16 v[156:159], v[116:119], v[244:247], v[156:159]
    v_mfma_f32_16x16x32_bf16 v[156:159], v[120:123], v[248:251], v[156:159]
    v_mfma_f32_16x16x32_bf16 v[156:159], v[124:127], v[252:255], v[156:159]
    s_waitcnt lgkmcnt(0)
    s_barrier
    ds_read_b128 v[64:67], v22 offset:32768
    v_max3_f32 v8, v128, v129, v130
    v_max3_f32 v9, v131, v132, v133
    ds_read_b128 v[68:71], v23 offset:32768
    v_max3_f32 v8, v8, v134, v135
    v_max3_f32 v9, v9, v136, v137
    ds_read_b128 v[72:75], v24 offset:32768
    v_max3_f32 v8, v8, v138, v139
    v_max3_f32 v9, v9, v140, v141
    ds_read_b128 v[76:79], v25 offset:32768
    v_max3_f32 v8, v8, v142, v143
    v_max3_f32 v9, v9, v144, v145
    ds_read_b128 v[80:83], v22 offset:36864
    v_max3_f32 v8, v8, v146, v147
    v_max3_f32 v9, v9, v148, v149
    ds_read_b128 v[84:87], v23 offset:36864
    v_max3_f32 v8, v8, v150, v151
    v_max3_f32 v9, v9, v152, v153
    v_max3_f32 v8, v8, v154, v155
    ds_read_b128 v[88:91], v24 offset:36864
    v_max3_f32 v9, v9, v156, v157
    v_max3_f32 v8, v8, v158, v159
    ds_read_b128 v[92:95], v25 offset:36864
    v_max_f32 v8, v8, v9
    v_mov_b32 v9, v8
    ds_read_b128 v[96:99], v22 offset:40960
    s_nop 0
    v_permlane32_swap_b32 v8, v9
    v_max_f32 v8, v8, v9
    ds_read_b128 v[100:103], v23 offset:40960
    v_mov_b32 v9, v8
    s_nop 1
    v_permlane16_swap_b32 v8, v9
    ds_read_b128 v[104:107], v24 offset:40960
    v_max_f32 v8, v8, v9
    v_sub_f32 v56, 0, v8
    ds_read_b128 v[108:111], v25 offset:40960
    v_sub_f32 v57, 0, v8
    v_sub_f32 v58, 0, v8
    v_sub_f32 v59, 0, v8
    s_waitcnt lgkmcnt(11)
    s_nop 0
    v_mfma_f32_16x16x32_bf16 v[160:163], v[64:67], v[240:243], v[56:59]
    ds_read_b128 v[112:115], v22 offset:45056
    v_sub_f32 v128, v128, v8
    v_sub_f32 v129, v129, v8
    s_waitcnt lgkmcnt(8)
    v_mfma_f32_16x16x32_bf16 v[160:163], v[68:71], v[244:247], v[160:163]
    ds_read_b128 v[116:119], v23 offset:45056
    v_sub_f32 v130, v130, v8
    v_sub_f32 v131, v131, v8
    v_sub_f32 v132, v132, v8
    v_mfma_f32_16x16x32_bf16 v[160:163], v[72:75], v[248:251], v[160:163]
    ds_read_b128 v[120:123], v24 offset:45056
    v_sub_f32 v133, v133, v8
    v_sub_f32 v134, v134, v8
    v_mfma_f32_16x16x32_bf16 v[160:163], v[76:79], v[252:255], v[160:163]
    ds_read_b128 v[124:127], v25 offset:45056
    v_sub_f32 v135, v135, v8
    v_exp_f32 v128, v128
    v_exp_f32 v129, v129
    v_mfma_f32_16x16x32_bf16 v[164:167], v[80:83], v[240:243], v[56:59]
    ds_read_b128 v[64:67], v22 offset:49152
    v_exp_f32 v130, v130
    v_exp_f32 v131, v131
    v_exp_f32 v132, v132
    s_waitcnt lgkmcnt(8)
    v_mfma_f32_16x16x32_bf16 v[164:167], v[84:87], v[244:247], v[164:167]
    ds_read_b128 v[68:71], v23 offset:49152
    v_exp_f32 v133, v133
    v_exp_f32 v134, v134
    v_mfma_f32_16x16x32_bf16 v[164:167], v[88:91], v[248:251], v[164:167]
    ds_read_b128 v[72:75], v24 offset:49152
    v_exp_f32 v135, v135
    v_cvt_pk_bf16_f32 v192, v128, v129
    v_cvt_pk_bf16_f32 v193, v130, v131
    v_mfma_f32_16x16x32_bf16 v[164:167], v[92:95], v[252:255], v[164:167]
    ds_read_b128 v[76:79], v25 offset:49152
    v_cvt_pk_bf16_f32 v194, v132, v133
    v_cvt_pk_bf16_f32 v195, v134, v135
    v_sub_f32 v136, v136, v8
    v_mfma_f32_16x16x32_bf16 v[168:171], v[96:99], v[240:243], v[56:59]
    ds_read_b128 v[80:83], v22 offset:53248
    v_sub_f32 v137, v137, v8
    v_sub_f32 v138, v138, v8
    s_waitcnt lgkmcnt(8)
    v_mfma_f32_16x16x32_bf16 v[168:171], v[100:103], v[244:247], v[168:171]
    ds_read_b128 v[84:87], v23 offset:53248
    v_sub_f32 v139, v139, v8
    v_sub_f32 v140, v140, v8
    v_sub_f32 v141, v141, v8
    v_mfma_f32_16x16x32_bf16 v[168:171], v[104:107], v[248:251], v[168:171]
    ds_read_b128 v[88:91], v24 offset:53248
    v_sub_f32 v142, v142, v8
    v_sub_f32 v143, v143, v8
    v_mfma_f32_16x16x32_bf16 v[168:171], v[108:111], v[252:255], v[168:171]
    ds_read_b128 v[92:95], v25 offset:53248
    v_exp_f32 v136, v136
    v_exp_f32 v137, v137
    v_exp_f32 v138, v138
    v_mfma_f32_16x16x32_bf16 v[172:175], v[112:115], v[240:243], v[56:59]
    ds_read_b128 v[96:99], v22 offset:57344
    v_exp_f32 v139, v139
    v_mfma_f32_16x16x32_bf16 v[52:55], v[48:51], v[192:195], 0
    v_exp_f32 v140, v140
    s_waitcnt lgkmcnt(8)
    v_mfma_f32_16x16x32_bf16 v[172:175], v[116:119], v[244:247], v[172:175]
    ds_read_b128 v[100:103], v23 offset:57344
    v_exp_f32 v141, v141
    v_exp_f32 v142, v142
    v_mfma_f32_16x16x32_bf16 v[172:175], v[120:123], v[248:251], v[172:175]
    ds_read_b128 v[104:107], v24 offset:57344
    v_exp_f32 v143, v143
    v_cvt_pk_bf16_f32 v196, v136, v137
    v_cvt_pk_bf16_f32 v197, v138, v139
    v_mfma_f32_16x16x32_bf16 v[172:175], v[124:127], v[252:255], v[172:175]
    ds_read_b128 v[108:111], v25 offset:57344
    v_cvt_pk_bf16_f32 v198, v140, v141
    v_cvt_pk_bf16_f32 v199, v142, v143
    v_sub_f32 v144, v144, v8
    v_mfma_f32_16x16x32_bf16 v[176:179], v[64:67], v[240:243], v[56:59]
    ds_read_b128 v[112:115], v22 offset:61440
    v_sub_f32 v145, v145, v8
    v_sub_f32 v146, v146, v8
    s_waitcnt lgkmcnt(8)
    v_mfma_f32_16x16x32_bf16 v[176:179], v[68:71], v[244:247], v[176:179]
    ds_read_b128 v[116:119], v23 offset:61440
    v_sub_f32 v147, v147, v8
    v_sub_f32 v148, v148, v8
    v_sub_f32 v149, v149, v8
    v_mfma_f32_16x16x32_bf16 v[176:179], v[72:75], v[248:251], v[176:179]
    ds_read_b128 v[120:123], v24 offset:61440
    v_sub_f32 v150, v150, v8
    v_sub_f32 v151, v151, v8
    v_mfma_f32_16x16x32_bf16 v[176:179], v[76:79], v[252:255], v[176:179]
    ds_read_b128 v[124:127], v25 offset:61440
    v_exp_f32 v144, v144
    v_exp_f32 v145, v145
    v_exp_f32 v146, v146
    v_mfma_f32_16x16x32_bf16 v[180:183], v[80:83], v[240:243], v[56:59]
    v_exp_f32 v147, v147
    v_mfma_f32_16x16x32_bf16 v[52:55], v[48:51], v[196:199], v[52:55]
    v_exp_f32 v148, v148
    s_waitcnt lgkmcnt(7)
    v_mfma_f32_16x16x32_bf16 v[180:183], v[84:87], v[244:247], v[180:183]
    v_exp_f32 v149, v149
    v_exp_f32 v150, v150
    v_mfma_f32_16x16x32_bf16 v[180:183], v[88:91], v[248:251], v[180:183]
    v_exp_f32 v151, v151
    v_cvt_pk_bf16_f32 v200, v144, v145
    v_cvt_pk_bf16_f32 v201, v146, v147
    v_mfma_f32_16x16x32_bf16 v[180:183], v[92:95], v[252:255], v[180:183]
    v_cvt_pk_bf16_f32 v202, v148, v149
    v_cvt_pk_bf16_f32 v203, v150, v151
    v_sub_f32 v152, v152, v8
    v_mfma_f32_16x16x32_bf16 v[184:187], v[96:99], v[240:243], v[56:59]
    v_sub_f32 v153, v153, v8
    v_sub_f32 v154, v154, v8
    s_waitcnt lgkmcnt(3)
    v_mfma_f32_16x16x32_bf16 v[184:187], v[100:103], v[244:247], v[184:187]
    v_sub_f32 v155, v155, v8
    v_sub_f32 v156, v156, v8
    v_sub_f32 v157, v157, v8
    v_mfma_f32_16x16x32_bf16 v[184:187], v[104:107], v[248:251], v[184:187]
    v_sub_f32 v158, v158, v8
    v_sub_f32 v159, v159, v8
    v_mfma_f32_16x16x32_bf16 v[184:187], v[108:111], v[252:255], v[184:187]
    v_exp_f32 v152, v152
    v_exp_f32 v153, v153
    v_exp_f32 v154, v154
    v_mfma_f32_16x16x32_bf16 v[188:191], v[112:115], v[240:243], v[56:59]
    v_exp_f32 v155, v155
    v_mfma_f32_16x16x32_bf16 v[52:55], v[48:51], v[200:203], v[52:55]
    v_exp_f32 v156, v156
    s_waitcnt lgkmcnt(0)
    v_mfma_f32_16x16x32_bf16 v[188:191], v[116:119], v[244:247], v[188:191]
    v_exp_f32 v157, v157
    v_exp_f32 v158, v158
    v_mfma_f32_16x16x32_bf16 v[188:191], v[120:123], v[248:251], v[188:191]
    v_exp_f32 v159, v159
    v_cvt_pk_bf16_f32 v204, v152, v153
    v_cvt_pk_bf16_f32 v205, v154, v155
    v_mfma_f32_16x16x32_bf16 v[188:191], v[124:127], v[252:255], v[188:191]
    v_cvt_pk_bf16_f32 v206, v156, v157
    v_cvt_pk_bf16_f32 v207, v158, v159
    s_nop 1
    v_mfma_f32_16x16x32_bf16 v[52:55], v[48:51], v[204:207], v[52:55]
    s_waitcnt lgkmcnt(0)
    s_barrier
    ds_read_b128 v[64:67], v26 offset:0
    v_max3_f32 v8, v160, v161, v162
    ds_read_b128 v[68:71], v27 offset:0
    v_max3_f32 v9, v163, v164, v165
    ds_read_b128 v[72:75], v28 offset:0
    v_max3_f32 v8, v8, v166, v167
    v_max3_f32 v9, v9, v168, v169
    ds_read_b128 v[76:79], v29 offset:0
    v_max3_f32 v8, v8, v170, v171
    ds_read_b128 v[80:83], v26 offset:4096
    v_max3_f32 v9, v9, v172, v173
    v_max3_f32 v8, v8, v174, v175
    ds_read_b128 v[84:87], v27 offset:4096
    v_max3_f32 v9, v9, v176, v177
    ds_read_b128 v[88:91], v28 offset:4096
    v_max3_f32 v8, v8, v178, v179
    ds_read_b128 v[92:95], v29 offset:4096
    v_max3_f32 v9, v9, v180, v181
    v_max3_f32 v8, v8, v182, v183
    ds_read_b128 v[96:99], v26 offset:8192
    v_max3_f32 v9, v9, v184, v185
    ds_read_b128 v[100:103], v27 offset:8192
    v_max3_f32 v8, v8, v186, v187
    v_max3_f32 v9, v9, v188, v189
    ds_read_b128 v[104:107], v28 offset:8192
    v_max3_f32 v8, v8, v190, v191
    ds_read_b128 v[108:111], v29 offset:8192
    v_max_f32 v8, v8, v9
    s_mov_b32 s76, 0
    v_cmp_lt_f32 vcc, s66, v8
    s_cbranch_vccnz Lz_1r
Lz_1:
    s_waitcnt lgkmcnt(11)
    v_mfma_f32_16x16x32_bf16 v[128:131], v[64:67], v[240:243], v[56:59]
    ds_read_b128 v[112:115], v26 offset:12288
    v_exp_f32 v160, v160
    s_waitcnt lgkmcnt(8)
    v_mfma_f32_16x16x32_bf16 v[128:131], v[68:71], v[244:247], v[128:131]
    ds_read_b128 v[116:119], v27 offset:12288
    v_exp_f32 v161, v161
    v_exp_f32 v162, v162
    v_mfma_f32_16x16x32_bf16 v[128:131], v[72:75], v[248:251], v[128:131]
    ds_read_b128 v[120:123], v28 offset:12288
    v_exp_f32 v163, v163
    v_mfma_f32_16x16x32_bf16 v[128:131], v[76:79], v[252:255], v[128:131]
    ds_read_b128 v[124:127], v29 offset:12288
    v_exp_f32 v164, v164
    v_exp_f32 v165, v165
    v_mfma_f32_16x16x32_bf16 v[132:135], v[80:83], v[240:243], v[56:59]
    ds_read_b128 v[64:67], v26 offset:16384
    v_exp_f32 v166, v166
    v_exp_f32 v167, v167
    s_waitcnt lgkmcnt(8)
    v_mfma_f32_16x16x32_bf16 v[132:135], v[84:87], v[244:247], v[132:135]
    ds_read_b128 v[68:71], v27 offset:16384
    v_cvt_pk_bf16_f32 v208, v160, v161
    v_mfma_f32_16x16x32_bf16 v[132:135], v[88:91], v[248:251], v[132:135]
    ds_read_b128 v[72:75], v28 offset:16384
    v_cvt_pk_bf16_f32 v209, v162, v163
    v_cvt_pk_bf16_f32 v210, v164, v165
    v_mfma_f32_16x16x32_bf16 v[132:135], v[92:95], v[252:255], v[132:135]
    ds_read_b128 v[76:79], v29 offset:16384
    v_cvt_pk_bf16_f32 v211, v166, v167
    v_exp_f32 v168, v168
    v_mfma_f32_16x16x32_bf16 v[136:139], v[96:99], v[240:243], v[56:59]
    ds_read_b128 v[80:83], v26 offset:20480
    v_exp_f32 v169, v169
    s_waitcnt lgkmcnt(8)
    v_mfma_f32_16x16x32_bf16 v[136:139], v[100:103], v[244:247], v[136:139]
    ds_read_b128 v[84:87], v27 offset:20480
    v_exp_f32 v170, v170
    v_exp_f32 v171, v171
    v_mfma_f32_16x16x32_bf16 v[136:139], v[104:107], v[248:251], v[136:139]
    ds_read_b128 v[88:91], v28 offset:20480
    v_mfma_f32_16x16x32_bf16 v[52:55], v[48:51], v[208:211], v[52:55]
    v_mfma_f32_16x16x32_bf16 v[136:139], v[108:111], v[252:255], v[136:139]
    ds_read_b128 v[92:95], v29 offset:20480
    v_exp_f32 v172, v172
    v_exp_f32 v173, v173
    v_mfma_f32_16x16x32_bf16 v[140:143], v[112:115], v[240:243], v[56:59]
    ds_read_b128 v[96:99], v26 offset:24576
    v_exp_f32 v174, v174
    v_exp_f32 v175, v175
    s_waitcnt lgkmcnt(8)
    v_mfma_f32_16x16x32_bf16 v[140:143], v[116:119], v[244:247], v[140:143]
    ds_read_b128 v[100:103], v27 offset:24576
    v_cvt_pk_bf16_f32 v212, v168, v169
    v_mfma_f32_16x16x32_bf16 v[140:143], v[120:123], v[248:251], v[140:143]
    ds_read_b128 v[104:107], v28 offset:24576
    v_cvt_pk_bf16_f32 v213, v170, v171
    v_cvt_pk_bf16_f32 v214, v172, v173
    v_mfma_f32_16x16x32_bf16 v[140:143], v[124:127], v[252:255], v[140:143]
    ds_read_b128 v[108:111], v29 offset:24576
    v_cvt_pk_bf16_f32 v215, v174, v175
    v_exp_f32 v176, v176
    v_mfma_f32_16x16x32_bf16 v[144:147], v[64:67], v[240:243], v[56:59]
    ds_read_b128 v[112:115], v26 offset:28672
    v_exp_f32 v177, v177
    s_waitcnt lgkmcnt(8)
    v_mfma_f32_16x16x32_bf16 v[144:147], v[68:71], v[244:247], v[144:147]
    ds_read_b128 v[116:119], v27 offset:28672
    v_exp_f32 v178, v178
    v_exp_f32 v179, v179
    v_mfma_f32_16x16x32_bf16 v[144:147], v[72:75], v[248:251], v[144:147]
    ds_read_b128 v[120:123], v28 offset:28672
    v_mfma_f32_16x16x32_bf16 v[52:55], v[48:51], v[212:215], v[52:55]
    v_mfma_f32_16x16x32_bf16 v[144:147], v[76:79], v[252:255], v[144:147]
    ds_read_b128 v[124:127], v29 offset:28672
    v_exp_f32 v180, v180
    v_exp_f32 v181, v181
    v_mfma_f32_16x16x32_bf16 v[148:151], v[80:83], v[240:243], v[56:59]
    v_exp_f32 v182, v182
    v_exp_f32 v183, v183
    s_waitcnt lgkmcnt(7)
    v_mfma_f32_16x16x32_bf16 v[148:151], v[84:87], v[244:247], v[148:151]
    v_cvt_pk_bf16_f32 v216, v176, v177
    v_mfma_f32_16x16x32_bf16 v[148:151], v[88:91], v[248:251], v[148:151]
    v_cvt_pk_bf16_f32 v217, v178, v179
    v_cvt_pk_bf16_f32 v218, v180, v181
    v_mfma_f32_16x16x32_bf16 v[148:151], v[92:95], v[252:255], v[148:151]
    v_cvt_pk_bf16_f32 v219, v182, v183
    v_exp_f32 v184, v184
    v_mfma_f32_16x16x32_bf16 v[152:155], v[96:99], v[240:243], v[56:59]
    v_exp_f32 v185, v185
    s_waitcnt lgkmcnt(3)
    v_mfma_f32_16x16x32_bf16 v[152:155], v[100:103], v[244:247], v[152:155]
    v_exp_f32 v186, v186
    v_exp_f32 v187, v187
    v_mfma_f32_16x16x32_bf16 v[152:155], v[104:107], v[248:251], v[152:155]
    v_mfma_f32_16x16x32_bf16 v[52:55], v[48:51], v[216:219], v[52:55]
    v_mfma_f32_16x16x32_bf16 v[152:155], v[108:111], v[252:255], v[152:155]
    v_exp_f32 v188, v188
    v_exp_f32 v189, v189
    v_mfma_f32_16x16x32_bf16 v[156:159], v[112:115], v[240:243], v[56:59]
    v_exp_f32 v190, v190
    v_exp_f32 v191, v191
    s_waitcnt lgkmcnt(0)
    v_mfma_f32_16x16x32_bf16 v[156:159], v[116:119], v[244:247], v[156:159]
    v_cvt_pk_bf16_f32 v220, v184, v185
    v_mfma_f32_16x16x32_bf16 v[156:159], v[120:123], v[248:251], v[156:159]
    v_cvt_pk_bf16_f32 v221, v186, v187
    v_cvt_pk_bf16_f32 v222, v188, v189
    v_mfma_f32_16x16x32_bf16 v[156:159], v[124:127], v[252:255], v[156:159]
    v_cvt_pk_bf16_f32 v223, v190, v191
    s_nop 1
    v_mfma_f32_16x16x32_bf16 v[52:55], v[48:51], v[220:223], v[52:55]
    s_waitcnt lgkmcnt(0)
    s_barrier
    ds_read_b128 v[64:67], v26 offset:32768
    v_max3_f32 v8, v128, v129, v130
    ds_read_b128 v[68:71], v27 offset:32768
    v_max3_f32 v9, v131, v132, v133
    s_branch L_pad2x
.p2align 12
L_pad2:
    s_setpc_b64 s[78:79]
    s_nop 0
L_pad2x:
    ds_read_b128 v[72:75], v28 offset:32768
    v_max3_f32 v8, v8, v134, v135
    v_max3_f32 v9, v9, v136, v137
    ds_read_b128 v[76:79], v29 offset:32768
    v_max3_f32 v8, v8, v138, v139
    ds_read_b128 v[80:83], v26 offset:36864
    v_max3_f32 v9, v9, v140, v141
    v_max3_f32 v8, v8, v142, v143
    ds_read_b128 v[84:87], v27 offset:36864
    v_max3_f32 v9, v9, v144, v145
    ds_read_b128 v[88:91], v28 offset:36864
    v_max3_f32 v8, v8, v146, v147
    ds_read_b128 v[92:95], v29 offset:36864
    v_max3_f32 v9, v9, v148, v149
    v_max3_f32 v8, v8, v150, v151
    ds_read_b128 v[96:99], v26 offset:40960
    v_max3_f32 v9, v9, v152, v153
    ds_read_b128 v[100:103], v27 offset:40960
    v_max3_f32 v8, v8, v154, v155
    v_max3_f32 v9, v9, v156, v157
    ds_read_b128 v[104:107], v28 offset:40960
    v_max3_f32 v8, v8, v158, v159
    ds_read_b128 v[108:111], v29 offset:40960
    v_max_f32 v8, v8, v9
    s_mov_b32 s77, 0
    v_cmp_lt_f32 vcc, s66, v8
    s_cbranch_vccnz Lz_2r
Lz_2:
    s_waitcnt lgkmcnt(11)
    v_mfma_f32_16x16x32_bf16 v[160:163], v[64:67], v[240:243], v[56:59]
    ds_read_b128 v[112:115], v26 offset:45056
    v_exp_f32 v128, v128
    s_waitcnt lgkmcnt(8)
    v_mfma_f32_16x16x32_bf16 v[160:163], v[68:71], v[244:247], v[160:163]
    ds_read_b128 v[116:119], v27 offset:45056
    v_exp_f32 v129, v129
    v_exp_f32 v130, v130
    v_mfma_f32_16x16x32_bf16 v[160:163], v[72:75], v[248:251], v[160:163]
    ds_read_b128 v[120:123], v28 offset:45056
    v_exp_f32 v131, v131
    v_mfma_f32_16x16x32_bf16 v[160:163], v[76:79], v[252:255], v[160:163]
    ds_read_b128 v[124:127], v29 offset:45056
    v_exp_f32 v132, v132
    v_exp_f32 v133, v133
    v_mfma_f32_16x16x32_bf16 v[164:167], v[80:83], v[240:243], v[56:59]
    ds_read_b128 v[64:67], v26 offset:49152
    v_exp_f32 v134, v134
    v_exp_f32 v135, v135
    s_waitcnt lgkmcnt(8)
    v_mfma_f32_16x16x32_bf16 v[164:167], v[84:87], v[244:247], v[164:167]
    ds_read_b128 v[68:71], v27 offset:49152
    v_cvt_pk_bf16_f32 v224, v128, v129
    v_mfma_f32_16x16x32_bf16 v[164:167], v[88:91], v[248:251], v[164:167]
    ds_read_b128 v[72:75], v28 offset:49152
    v_cvt_pk_bf16_f32 v225, v130, v131
    v_cvt_pk_bf16_f32 v226, v132, v133
    v_mfma_f32_16x16x32_bf16 v[164:167], v[92:95], v[252:255], v[164:167]
    ds_read_b128 v[76:79], v29 offset:49152
    v_cvt_pk_bf16_f32 v227, v134, v135
    v_exp_f32 v136, v136
    v_mfma_f32_16x16x32_bf16 v[168:171], v[96:99], v[240:243], v[56:59]
    ds_read_b128 v[80:83], v26 offset:53248
    v_exp_f32 v137, v137
    s_waitcnt lgkmcnt(8)
    v_mfma_f32_16x16x32_bf16 v[168:171], v[100:103], v[244:247], v[168:171]
    ds_read_b128 v[84:87], v27 offset:53248
    v_exp_f32 v138, v138
    v_exp_f32 v139, v139
    v_mfma_f32_16x16x32_bf16 v[168:171], v[104:107], v[248:251], v[168:171]
    ds_read_b128 v[88:91], v28 offset:53248
    v_mfma_f32_16x16x32_bf16 v[52:55], v[48:51], v[224:227], v[52:55]
    v_mfma_f32_16x16x32_bf16 v[168:171], v[108:111], v[252:255], v[168:171]
    ds_read_b128 v[92:95], v29 offset:53248
    v_exp_f32 v140, v140
    v_exp_f32 v141, v141
    v_mfma_f32_16x16x32_bf16 v[172:175], v[112:115], v[240:243], v[56:59]
    ds_read_b128 v[96:99], v26 offset:57344
    v_exp_f32 v142, v142
    v_exp_f32 v143, v143
    s_waitcnt lgkmcnt(8)
    v_mfma_f32_16x16x32_bf16 v[172:175], v[116:119], v[244:247], v[172:175]
    ds_read_b128 v[100:103], v27 offset:57344
    v_cvt_pk_bf16_f32 v228, v136, v137
    v_mfma_f32_16x16x32_bf16 v[172:175], v[120:123], v[248:251], v[172:175]
    ds_read_b128 v[104:107], v28 offset:57344
    v_cvt_pk_bf16_f32 v229, v138, v139
    v_cvt_pk_bf16_f32 v230, v140, v141
    v_mfma_f32_16x16x32_bf16 v[172:175], v[124:127], v[252:255], v[172:175]
    ds_read_b128 v[108:111], v29 offset:57344
    v_cvt_pk_bf16_f32 v231, v142, v143
    v_exp_f32 v144, v144
    v_mfma_f32_16x16x32_bf16 v[176:179], v[64:67], v[240:243], v[56:59]
    ds_read_b128 v[112:115], v26 offset:61440
    v_exp_f32 v145, v145
    s_waitcnt lgkmcnt(8)
    v_mfma_f32_16x16x32_bf16 v[176:179], v[68:71], v[244:247], v[176:179]
    ds_read_b128 v[116:119], v27 offset:61440
    v_exp_f32 v146, v146
    v_exp_f32 v147, v147
    v_mfma_f32_16x16x32_bf16 v[176:179], v[72:75], v[248:251], v[176:179]
    ds_read_b128 v[120:123], v28 offset:61440
    v_mfma_f32_16x16x32_bf16 v[52:55], v[48:51], v[228:231], v[52:55]
    v_mfma_f32_16x16x32_bf16 v[176:179], v[76:79], v[252:255], v[176:179]
    ds_read_b128 v[124:127], v29 offset:61440
    v_exp_f32 v148, v148
    v_exp_f32 v149, v149
    v_mfma_f32_16x16x32_bf16 v[180:183], v[80:83], v[240:243], v[56:59]
    v_exp_f32 v150, v150
    v_exp_f32 v151, v151
    s_waitcnt lgkmcnt(7)
    v_mfma_f32_16x16x32_bf16 v[180:183], v[84:87], v[244:247], v[180:183]
    v_cvt_pk_bf16_f32 v232, v144, v145
    v_mfma_f32_16x16x32_bf16 v[180:183], v[88:91], v[248:251], v[180:183]
    v_cvt_pk_bf16_f32 v233, v146, v147
    v_cvt_pk_bf16_f32 v234, v148, v149
    v_mfma_f32_16x16x32_bf16 v[180:183], v[92:95], v[252:255], v[180:183]
    v_cvt_pk_bf16_f32 v235, v150, v151
    v_exp_f32 v152, v152
    v_mfma_f32_16x16x32_bf16 v[184:187], v[96:99], v[240:243], v[56:59]
    v_exp_f32 v153, v153
    s_waitcnt lgkmcnt(3)
    v_mfma_f32_16x16x32_bf16 v[184:187], v[100:103], v[244:247], v[184:187]
    v_exp_f32 v154, v154
    v_exp_f32 v155, v155
    v_mfma_f32_16x16x32_bf16 v[184:187], v[104:107], v[248:251], v[184:187]
    v_mfma_f32_16x16x32_bf16 v[52:55], v[48:51], v[232:235], v[52:55]
    v_mfma_f32_16x16x32_bf16 v[184:187], v[108:111], v[252:255], v[184:187]
    v_exp_f32 v156, v156
    v_exp_f32 v157, v157
    v_mfma_f32_16x16x32_bf16 v[188:191], v[112:115], v[240:243], v[56:59]
    v_exp_f32 v158, v158
    v_exp_f32 v159, v159
    s_waitcnt lgkmcnt(0)
    v_mfma_f32_16x16x32_bf16 v[188:191], v[116:119], v[244:247], v[188:191]
    v_cvt_pk_bf16_f32 v236, v152, v153
    v_mfma_f32_16x16x32_bf16 v[188:191], v[120:123], v[248:251], v[188:191]
    v_cvt_pk_bf16_f32 v237, v154, v155
    v_cvt_pk_bf16_f32 v238, v156, v157
    v_mfma_f32_16x16x32_bf16 v[188:191], v[124:127], v[252:255], v[188:191]
    v_cvt_pk_bf16_f32 v239, v158, v159
    s_nop 1
    v_mfma_f32_16x16x32_bf16 v[52:55], v[48:51], v[236:239], v[52:55]
    s_waitcnt lgkmcnt(0)
    s_barrier
    ds_read_b64_tr_b16 v[64:65], v32 offset:0
    ds_read_b64_tr_b16 v[66:67], v32 offset:4096
    v_max3_f32 v8, v160, v161, v162
    ds_read_b64_tr_b16 v[68:69], v33 offset:0
    ds_read_b64_tr_b16 v[70:71], v33 offset:4096
    v_max3_f32 v9, v163, v164, v165
    v_max3_f32 v8, v8, v166, v167
    ds_read_b64_tr_b16 v[72:73], v34 offset:0
    ds_read_b64_tr_b16 v[74:75], v34 offset:4096
    v_max3_f32 v9, v9, v168, v169
    v_max3_f32 v8, v8, v170, v171
    ds_read_b64_tr_b16 v[76:77], v35 offset:0
    ds_read_b64_tr_b16 v[78:79], v35 offset:4096
    v_max3_f32 v9, v9, v172, v173
    ds_read_b64_tr_b16 v[80:81], v36 offset:0
    ds_read_b64_tr_b16 v[82:83], v36 offset:4096
    v_max3_f32 v8, v8, v174, v175
    v_max3_f32 v9, v9, v176, v177
    ds_read_b64_tr_b16 v[84:85], v37 offset:0
    ds_read_b64_tr_b16 v[86:87], v37 offset:4096
    v_max3_f32 v8, v8, v178, v179
    v_max3_f32 v9, v9, v180, v181
    ds_read_b64_tr_b16 v[88:89], v38 offset:0
    ds_read_b64_tr_b16 v[90:91], v38 offset:4096
    v_max3_f32 v8, v8, v182, v183
    ds_read_b64_tr_b16 v[92:93], v39 offset:0
    ds_read_b64_tr_b16 v[94:95], v39 offset:4096
    v_max3_f32 v9, v9, v184, v185
    v_max3_f32 v8, v8, v186, v187
    ds_read_b64_tr_b16 v[96:97], v32 offset:8192
    ds_read_b64_tr_b16 v[98:99], v32 offset:12288
    v_max3_f32 v9, v9, v188, v189
    v_max3_f32 v8, v8, v190, v191
    ds_read_b64_tr_b16 v[100:101], v33 offset:8192
    ds_read_b64_tr_b16 v[102:103], v33 offset:12288
    v_max_f32 v8, v8, v9
    s_mov_b32 s78, 0
    v_cmp_lt_f32 vcc, s66, v8
    s_cbranch_vccnz Lz_3r
Lz_3:
    s_waitcnt lgkmcnt(15)
    v_mfma_f32_16x16x32_bf16 v[128:131], v[64:67], v[192:195], 0
    ds_read_b64_tr_b16 v[104:105], v34 offset:8192
    ds_read_b64_tr_b16 v[106:107], v34 offset:12288
    s_waitcnt lgkmcnt(12)
    v_mfma_f32_16x16x32_bf16 v[132:135], v[68:71], v[192:195], 0
    ds_read_b64_tr_b16 v[108:109], v35 offset:8192
    ds_read_b64_tr_b16 v[110:111], v35 offset:12288
    v_exp_f32 v160, v160
    v_mfma_f32_16x16x32_bf16 v[136:139], v[72:75], v[192:195], 0
    ds_read_b64_tr_b16 v[112:113], v36 offset:8192
    ds_read_b64_tr_b16 v[114:115], v36 offset:12288
    v_exp_f32 v161, v161
    v_mfma_f32_16x16x32_bf16 v[140:143], v[76:79], v[192:195], 0
    ds_read_b64_tr_b16 v[116:117], v37 offset:8192
    ds_read_b64_tr_b16 v[118:119], v37 offset:12288
    v_exp_f32 v162, v162
    v_mfma_f32_16x16x32_bf16 v[144:147], v[80:83], v[192:195], 0
    ds_read_b64_tr_b16 v[120:121], v38 offset:8192
    ds_read_b64_tr_b16 v[122:123], v38 offset:12288
    v_exp_f32 v163, v163
    s_waitcnt lgkmcnt(12)
    v_mfma_f32_16x16x32_bf16 v[148:151], v[84:87], v[192:195], 0
    ds_read_b64_tr_b16 v[124:125], v39 offset:8192
    ds_read_b64_tr_b16 v[126:127], v39 offset:12288
    v_mfma_f32_16x16x32_bf16 v[152:155], v[88:91], v[192:195], 0
    ds_read_b64_tr_b16 v[64:65], v32 offset:16384
    ds_read_b64_tr_b16 v[66:67], v32 offset:20480
    v_exp_f32 v164, v164
    v_mfma_f32_16x16x32_bf16 v[156:159], v[92:95], v[192:195], 0
    ds_read_b64_tr_b16 v[68:69], v33 offset:16384
    ds_read_b64_tr_b16 v[70:71], v33 offset:20480
    v_exp_f32 v165, v165
    v_mfma_f32_16x16x32_bf16 v[128:131], v[96:99], v[196:199], v[128:131]
    ds_read_b64_tr_b16 v[72:73], v34 offset:16384
    ds_read_b64_tr_b16 v[74:75], v34 offset:20480
    v_exp_f32 v166, v166
    s_waitcnt lgkmcnt(12)
    v_mfma_f32_16x16x32_bf16 v[132:135], v[100:103], v[196:199], v[132:135]
    ds_read_b64_tr_b16 v[76:77], v35 offset:16384
    ds_read_b64_tr_b16 v[78:79], v35 offset:20480
    v_exp_f32 v167, v167
    v_mfma_f32_16x16x32_bf16 v[136:139], v[104:107], v[196:199], v[136:139]
    ds_read_b64_tr_b16 v[80:81], v36 offset:16384
    ds_read_b64_tr_b16 v[82:83], v36 offset:20480
    v_mfma_f32_16x16x32_bf16 v[140:143], v[108:111], v[196:199], v[140:143]
    ds_read_b64_tr_b16 v[84:85], v37 offset:16384
    ds_read_b64_tr_b16 v[86:87], v37 offset:20480
    v_cvt_pk_bf16_f32 v240, v160, v161
    v_mfma_f32_16x16x32_bf16 v[144:147], v[112:115], v[196:199], v[144:147]
    ds_read_b64_tr_b16 v[88:89], v38 offset:16384
    ds_read_b64_tr_b16 v[90:91], v38 offset:20480
    v_cvt_pk_bf16_f32 v241, v162, v163
    s_waitcnt lgkmcnt(12)
    v_mfma_f32_16x16x32_bf16 v[148:151], v[116:119], v[196:199], v[148:151]
    ds_read_b64_tr_b16 v[92:93], v39 offset:16384
    ds_read_b64_tr_b16 v[94:95], v39 offset:20480
    v_cvt_pk_bf16_f32 v242, v164, v165
    v_mfma_f32_16x16x32_bf16 v[152:155], v[120:123], v[196:199], v[152:155]
    ds_read_b64_tr_b16 v[96:97], v32 offset:24576
    ds_read_b64_tr_b16 v[98:99], v32 offset:28672
    v_cvt_pk_bf16_f32 v243, v166, v167
    v_mfma_f32_16x16x32_bf16 v[156:159], v[124:127], v[196:199], v[156:159]
    ds_read_b64_tr_b16 v[100:101], v33 offset:24576
    ds_read_b64_tr_b16 v[102:103], v33 offset:28672
    v_exp_f32 v168, v168
    v_mfma_f32_16x16x32_bf16 v[128:131], v[64:67], v[200:203], v[128:131]
    ds_read_b64_tr_b16 v[104:105], v34 offset:24576
    ds_read_b64_tr_b16 v[106:107], v34 offset:28672
    s_waitcnt lgkmcnt(12)
    v_mfma_f32_16x16x32_bf16 v[132:135], v[68:71], v[200:203], v[132:135]
    ds_read_b64_tr_b16 v[108:109], v35 offset:24576
    ds_read_b64_tr_b16 v[110:111], v35 offset:28672
    v_exp_f32 v169, v169
    v_mfma_f32_16x16x32_bf16 v[136:139], v[72:75], v[200:203], v[136:139]
    ds_read_b64_tr_b16 v[112:113], v36 offset:24576
    ds_read_b64_tr_b16 v[114:115], v36 offset:28672
    v_exp_f32 v170, v170
    v_mfma_f32_16x16x32_bf16 v[140:143], v[76:79], v[200:203], v[140:143]
    ds_read_b64_tr_b16 v[116:117], v37 offset:24576
    ds_read_b64_tr_b16 v[118:119], v37 offset:28672
    v_exp_f32 v171, v171
    v_mfma_f32_16x16x32_bf16 v[144:147], v[80:83], v[200:203], v[144:147]
    ds_read_b64_tr_b16 v[120:121], v38 offset:24576
    ds_read_b64_tr_b16 v[122:123], v38 offset:28672
    v_mfma_f32_16x16x32_bf16 v[52:55], v[48:51], v[240:243], v[52:55]
    s_waitcnt lgkmcnt(12)
    v_mfma_f32_16x16x32_bf16 v[148:151], v[84:87], v[200:203], v[148:151]
    ds_read_b64_tr_b16 v[124:125], v39 offset:24576
    ds_read_b64_tr_b16 v[126:127], v39 offset:28672
    v_mfma_f32_16x16x32_bf16 v[152:155], v[88:91], v[200:203], v[152:155]
    v_exp_f32 v172, v172
    v_mfma_f32_16x16x32_bf16 v[156:159], v[92:95], v[200:203], v[156:159]
    v_exp_f32 v173, v173
    v_mfma_f32_16x16x32_bf16 v[128:131], v[96:99], v[204:207], v[128:131]
    v_exp_f32 v174, v174
    s_waitcnt lgkmcnt(6)
    v_mfma_f32_16x16x32_bf16 v[132:135], v[100:103], v[204:207], v[132:135]
    v_exp_f32 v175, v175
    v_mfma_f32_16x16x32_bf16 v[136:139], v[104:107], v[204:207], v[136:139]
    v_mfma_f32_16x16x32_bf16 v[140:143], v[108:111], v[204:207], v[140:143]
    v_cvt_pk_bf16_f32 v244, v168, v169
    v_mfma_f32_16x16x32_bf16 v[144:147], v[112:115], v[204:207], v[144:147]
    v_cvt_pk_bf16_f32 v245, v170, v171
    s_waitcnt lgkmcnt(0)
    v_mfma_f32_16x16x32_bf16 v[148:151], v[116:119], v[204:207], v[148:151]
    v_cvt_pk_bf16_f32 v246, v172, v173
    v_mfma_f32_16x16x32_bf16 v[152:155], v[120:123], v[204:207], v[152:155]
    v_cvt_pk_bf16_f32 v247, v174, v175
    v_mfma_f32_16x16x32_bf16 v[156:159], v[124:127], v[204:207], v[156:159]
    v_exp_f32 v176, v176
    s_waitcnt lgkmcnt(0)
    s_barrier
    ds_read_b64_tr_b16 v[64:65], v32 offset:32768
    ds_read_b64_tr_b16 v[66:67], v32 offset:36864
    s_cmp_lg_u32 s76, 0
    s_cbranch_scc1 Ly_4r
Ly_4:
    ds_read_b64_tr_b16 v[68:69], v33 offset:32768
    ds_read_b64_tr_b16 v[70:71], v33 offset:36864
    v_exp_f32 v177, v177
    ds_read_b64_tr_b16 v[72:73], v34 offset:32768
    ds_read_b64_tr_b16 v[74:75], v34 offset:36864
    v_exp_f32 v178, v178
    ds_read_b64_tr_b16 v[76:77], v35 offset:32768
    ds_read_b64_tr_b16 v[78:79], v35 offset:36864
    v_exp_f32 v179, v179
    ds_read_b64_tr_b16 v[80:81], v36 offset:32768
    ds_read_b64_tr_b16 v[82:83], v36 offset:36864
    v_mfma_f32_16x16x32_bf16 v[52:55], v[48:51], v[244:247], v[52:55]
    ds_read_b64_tr_b16 v[84:85], v37 offset:32768
    ds_read_b64_tr_b16 v[86:87], v37 offset:36864
    v_exp_f32 v180, v180
    ds_read_b64_tr_b16 v[88:89], v38 offset:32768
    ds_read_b64_tr_b16 v[90:91], v38 offset:36864
    v_exp_f32 v181, v181
    ds_read_b64_tr_b16 v[92:93], v39 offset:32768
    ds_read_b64_tr_b16 v[94:95], v39 offset:36864
    v_exp_f32 v182, v182
    ds_read_b64_tr_b16 v[96:97], v32 offset:40960
    ds_read_b64_tr_b16 v[98:99], v32 offset:45056
    v_exp_f32 v183, v183
    ds_read_b64_tr_b16 v[100:101], v33 offset:40960
    ds_read_b64_tr_b16 v[102:103], v33 offset:45056
    v_cvt_pk_bf16_f32 v248, v176, v177
    v_cvt_pk_bf16_f32 v249, v178, v179
    s_waitcnt lgkmcnt(15)
    v_mfma_f32_16x16x32_bf16 v[128:131], v[64:67], v[208:211], v[128:131]
    ds_read_b64_tr_b16 v[104:105], v34 offset:40960
    ds_read_b64_tr_b16 v[106:107], v34 offset:45056
    s_waitcnt lgkmcnt(12)
    v_mfma_f32_16x16x32_bf16 v[132:135], v[68:71], v[208:211], v[132:135]
    ds_read_b64_tr_b16 v[108:109], v35 offset:40960
    ds_read_b64_tr_b16 v[110:111], v35 offset:45056
    v_cvt_pk_bf16_f32 v250, v180, v181
    v_mfma_f32_16x16x32_bf16 v[136:139], v[72:75], v[208:211], v[136:139]
    ds_read_b64_tr_b16 v[112:113], v36 offset:40960
    ds_read_b64_tr_b16 v[114:115], v36 offset:45056
    v_mfma_f32_16x16x32_bf16 v[140:143], v[76:79], v[208:211], v[140:143]
    ds_read_b64_tr_b16 v[116:117], v37 offset:40960
    ds_read_b64_tr_b16 v[118:119], v37 offset:45056
    v_cvt_pk_bf16_f32 v251, v182, v183
    v_mfma_f32_16x16x32_bf16 v[144:147], v[80:83], v[208:211], v[144:147]
    ds_read_b64_tr_b16 v[120:121], v38 offset:40960
    ds_read_b64_tr_b16 v[122:123], v38 offset:45056
    s_waitcnt lgkmcnt(12)
    v_mfma_f32_16x16x32_bf16 v[148:151], v[84:87], v[208:211], v[148:151]
    ds_read_b64_tr_b16 v[124:125], v39 offset:40960
    ds_read_b64_tr_b16 v[126:127], v39 offset:45056
    v_exp_f32 v184, v184
    v_mfma_f32_16x16x32_bf16 v[152:155], v[88:91], v[208:211], v[152:155]
    ds_read_b64_tr_b16 v[64:65], v32 offset:49152
    ds_read_b64_tr_b16 v[66:67], v32 offset:53248
    v_mfma_f32_16x16x32_bf16 v[156:159], v[92:95], v[208:211], v[156:159]
    ds_read_b64_tr_b16 v[68:69], v33 offset:49152
    ds_read_b64_tr_b16 v[70:71], v33 offset:53248
    v_exp_f32 v185, v185
    v_mfma_f32_16x16x32_bf16 v[128:131], v[96:99], v[212:215], v[128:131]
    ds_read_b64_tr_b16 v[72:73], v34 offset:49152
    ds_read_b64_tr_b16 v[74:75], v34 offset:53248
    s_waitcnt lgkmcnt(12)
    v_mfma_f32_16x16x32_bf16 v[132:135], v[100:103], v[212:215], v[132:135]
    ds_read_b64_tr_b16 v[76:77], v35 offset:49152
    ds_read_b64_tr_b16 v[78:79], v35 offset:53248
    v_exp_f32 v186, v186
    v_mfma_f32_16x16x32_bf16 v[136:139], v[104:107], v[212:215], v[136:139]
    ds_read_b64_tr_b16 v[80:81], v36 offset:49152
    ds_read_b64_tr_b16 v[82:83], v36 offset:53248
    v_mfma_f32_16x16x32_bf16 v[140:143], v[108:111], v[212:215], v[140:143]
    ds_read_b64_tr_b16 v[84:85], v37 offset:49152
    ds_read_b64_tr_b16 v[86:87], v37 offset:53248
    v_exp_f32 v187, v187
    v_mfma_f32_16x16x32_bf16 v[144:147], v[112:115], v[212:215], v[144:147]
    ds_read_b64_tr_b16 v[88:89], v38 offset:49152
    ds_read_b64_tr_b16 v[90:91], v38 offset:53248
    s_waitcnt lgkmcnt(12)
    v_mfma_f32_16x16x32_bf16 v[148:151], v[116:119], v[212:215], v[148:151]
    ds_read_b64_tr_b16 v[92:93], v39 offset:49152
    ds_read_b64_tr_b16 v[94:95], v39 offset:53248
    v_mfma_f32_16x16x32_bf16 v[52:55], v[48:51], v[248:251], v[52:55]
    v_mfma_f32_16x16x32_bf16 v[152:155], v[120:123], v[212:215], v[152:155]
    ds_read_b64_tr_b16 v[96:97], v32 offset:57344
    ds_read_b64_tr_b16 v[98:99], v32 offset:61440
    v_mfma_f32_16x16x32_bf16 v[156:159], v[124:127], v[212:215], v[156:159]
    ds_read_b64_tr_b16 v[100:101], v33 offset:57344
    ds_read_b64_tr_b16 v[102:103], v33 offset:61440
    v_exp_f32 v188, v188
    v_mfma_f32_16x16x32_bf16 v[128:131], v[64:67], v[216:219], v[128:131]
    ds_read_b64_tr_b16 v[104:105], v34 offset:57344
    ds_read_b64_tr_b16 v[106:107], v34 offset:61440
    s_waitcnt lgkmcnt(12)
    v_mfma_f32_16x16x32_bf16 v[132:135], v[68:71], v[216:219], v[132:135]
    ds_read_b64_tr_b16 v[108:109], v35 offset:57344
    ds_read_b64_tr_b16 v[110:111], v35 offset:61440
    v_exp_f32 v189, v189
    v_mfma_f32_16x16x32_bf16 v[136:139], v[72:75], v[216:219], v[136:139]
    ds_read_b64_tr_b16 v[112:113], v36 offset:57344
    ds_read_b64_tr_b16 v[114:115], v36 offset:61440
    v_mfma_f32_16x16x32_bf16 v[140:143], v[76:79], v[216:219], v[140:143]
    ds_read_b64_tr_b16 v[116:117], v37 offset:57344
    ds_read_b64_tr_b16 v[118:119], v37 offset:61440
    v_exp_f32 v190, v190
    v_mfma_f32_16x16x32_bf16 v[144:147], v[80:83], v[216:219], v[144:147]
    ds_read_b64_tr_b16 v[120:121], v38 offset:57344
    ds_read_b64_tr_b16 v[122:123], v38 offset:61440
    s_waitcnt lgkmcnt(12)
    v_mfma_f32_16x16x32_bf16 v[148:151], v[84:87], v[216:219], v[148:151]
    ds_read_b64_tr_b16 v[124:125], v39 offset:57344
    ds_read_b64_tr_b16 v[126:127], v39 offset:61440
    v_exp_f32 v191, v191
    v_mfma_f32_16x16x32_bf16 v[152:155], v[88:91], v[216:219], v[152:155]
    v_mfma_f32_16x16x32_bf16 v[156:159], v[92:95], v[216:219], v[156:159]
    v_cvt_pk_bf16_f32 v252, v184, v185
    v_mfma_f32_16x16x32_bf16 v[128:131], v[96:99], v[220:223], v[128:131]
    s_waitcnt lgkmcnt(6)
    v_mfma_f32_16x16x32_bf16 v[132:135], v[100:103], v[220:223], v[132:135]
    v_cvt_pk_bf16_f32 v253, v186, v187
    v_mfma_f32_16x16x32_bf16 v[136:139], v[104:107], v[220:223], v[136:139]
    v_mfma_f32_16x16x32_bf16 v[140:143], v[108:111], v[220:223], v[140:143]
    v_cvt_pk_bf16_f32 v254, v188, v189
    v_mfma_f32_16x16x32_bf16 v[144:147], v[112:115], v[220:223], v[144:147]
    s_waitcnt lgkmcnt(0)
    v_mfma_f32_16x16x32_bf16 v[148:151], v[116:119], v[220:223], v[148:151]
    v_cvt_pk_bf16_f32 v255, v190, v191
    v_mfma_f32_16x16x32_bf16 v[152:155], v[120:123], v[220:223], v[152:155]
    v_mfma_f32_16x16x32_bf16 v[156:159], v[124:127], v[220:223], v[156:159]
    v_mfma_f32_16x16x32_bf16 v[52:55], v[48:51], v[252:255], v[52:55]
    s_waitcnt lgkmcnt(0)
    s_barrier
    ds_read_b64_tr_b16 v[64:65], v40 offset:0
    ds_read_b64_tr_b16 v[66:67], v40 offset:4096
    ds_read_b64_tr_b16 v[68:69], v41 offset:0
    ds_read_b64_tr_b16 v[70:71], v41 offset:4096
    ds_read_b64_tr_b16 v[72:73], v42 offset:0
    ds_read_b64_tr_b16 v[74:75], v42 offset:4096
    ds_read_b64_tr_b16 v[76:77], v43 offset:0
    ds_read_b64_tr_b16 v[78:79], v43 offset:4096
    ds_read_b64_tr_b16 v[80:81], v44 offset:0
    ds_read_b64_tr_b16 v[82:83], v44 offset:4096
    ds_read_b64_tr_b16 v[84:85], v45 offset:0
    ds_read_b64_tr_b16 v[86:87], v45 offset:4096
    ds_read_b64_tr_b16 v[88:89], v46 offset:0
    ds_read_b64_tr_b16 v[90:91], v46 offset:4096
    ds_read_b64_tr_b16 v[92:93], v47 offset:0
    ds_read_b64_tr_b16 v[94:95], v47 offset:4096
    ds_read_b64_tr_b16 v[96:97], v40 offset:8192
    ds_read_b64_tr_b16 v[98:99], v40 offset:12288
    ds_read_b64_tr_b16 v[100:101], v41 offset:8192
    ds_read_b64_tr_b16 v[102:103], v41 offset:12288
    s_cmp_lg_u32 s77, 0
    s_cbranch_scc1 Ly_5r
Ly_5:
    s_waitcnt lgkmcnt(15)
    v_mfma_f32_16x16x32_bf16 v[128:131], v[64:67], v[224:227], v[128:131]
    ds_read_b64_tr_b16 v[104:105], v42 offset:8192
    ds_read_b64_tr_b16 v[106:107], v42 offset:12288
    s_waitcnt lgkmcnt(12)
    v_mfma_f32_16x16x32_bf16 v[132:135], v[68:71], v[224:227], v[132:135]
    ds_read_b64_tr_b16 v[108:109], v43 offset:8192
    ds_read_b64_tr_b16 v[110:111], v43 offset:12288
    v_mfma_f32_16x16x32_bf16 v[136:139], v[72:75], v[224:227], v[136:139]
    ds_read_b64_tr_b16 v[112:113], v44 offset:8192
    ds_read_b64_tr_b16 v[114:115], v44 offset:12288
    v_mfma_f32_16x16x32_bf16 v[140:143], v[76:79], v[224:227], v[140:143]
    ds_read_b64_tr_b16 v[116:117], v45 offset:8192
    ds_read_b64_tr_b16 v[118:119], v45 offset:12288
    s_lshr_b32 s67, s53, 1
    s_lshl_b32 s67, s67, 11
    v_add_u32 v22, s67, v5
    v_mfma_f32_16x16x32_bf16 v[144:147], v[80:83], v[224:227], v[144:147]
    ds_read_b64_tr_b16 v[120:121], v46 offset:8192
    ds_read_b64_tr_b16 v[122:123], v46 offset:12288
    s_waitcnt lgkmcnt(12)
    v_mfma_f32_16x16x32_bf16 v[148:151], v[84:87], v[224:227], v[148:151]
    ds_read_b64_tr_b16 v[124:125], v47 offset:8192
    ds_read_b64_tr_b16 v[126:127], v47 offset:12288
    v_mfma_f32_16x16x32_bf16 v[152:155], v[88:91], v[224:227], v[152:155]
    ds_read_b64_tr_b16 v[64:65], v40 offset:16384
    ds_read_b64_tr_b16 v[66:67], v40 offset:20480
    v_mfma_f32_16x16x32_bf16 v[156:159], v[92:95], v[224:227], v[156:159]
    ds_read_b64_tr_b16 v[68:69], v41 offset:16384
    ds_read_b64_tr_b16 v[70:71], v41 offset:20480
    s_add_u32 s67, s67, 2048
    s_and_b32 s67, s67, 16383
    v_add_u32 v23, s67, v5
    v_mfma_f32_16x16x32_bf16 v[128:131], v[96:99], v[228:231], v[128:131]
    ds_read_b64_tr_b16 v[72:73], v42 offset:16384
    ds_read_b64_tr_b16 v[74:75], v42 offset:20480
    s_waitcnt lgkmcnt(12)
    v_mfma_f32_16x16x32_bf16 v[132:135], v[100:103], v[228:231], v[132:135]
    ds_read_b64_tr_b16 v[76:77], v43 offset:16384
    ds_read_b64_tr_b16 v[78:79], v43 offset:20480
    v_mfma_f32_16x16x32_bf16 v[136:139], v[104:107], v[228:231], v[136:139]
    ds_read_b64_tr_b16 v[80:81], v44 offset:16384
    ds_read_b64_tr_b16 v[82:83], v44 offset:20480
    v_mfma_f32_16x16x32_bf16 v[140:143], v[108:111], v[228:231], v[140:143]
    ds_read_b64_tr_b16 v[84:85], v45 offset:16384
    ds_read_b64_tr_b16 v[86:87], v45 offset:20480
    s_add_u32 s67, s67, 2048
    s_and_b32 s67, s67, 16383
    v_add_u32 v24, s67, v5
    v_mfma_f32_16x16x32_bf16 v[144:147], v[112:115], v[228:231], v[144:147]
    ds_read_b64_tr_b16 v[88:89], v46 offset:16384
    ds_read_b64_tr_b16 v[90:91], v46 offset:20480
    s_waitcnt lgkmcnt(12)
    v_mfma_f32_16x16x32_bf16 v[148:151], v[116:119], v[228:231], v[148:151]
    ds_read_b64_tr_b16 v[92:93], v47 offset:16384
    ds_read_b64_tr_b16 v[94:95], v47 offset:20480
    v_mfma_f32_16x16x32_bf16 v[152:155], v[120:123], v[228:231], v[152:155]
    ds_read_b64_tr_b16 v[96:97], v40 offset:24576
    ds_read_b64_tr_b16 v[98:99], v40 offset:28672
    v_mfma_f32_16x16x32_bf16 v[156:159], v[124:127], v[228:231], v[156:159]
    ds_read_b64_tr_b16 v[100:101], v41 offset:24576
    ds_read_b64_tr_b16 v[102:103], v41 offset:28672
    s_add_u32 s67, s67, 2048
    s_and_b32 s67, s67, 16383
    v_add_u32 v25, s67, v5
    v_mfma_f32_16x16x32_bf16 v[128:131], v[64:67], v[232:235], v[128:131]
    ds_read_b64_tr_b16 v[104:105], v42 offset:24576
    ds_read_b64_tr_b16 v[106:107], v42 offset:28672
    s_waitcnt lgkmcnt(12)
    v_mfma_f32_16x16x32_bf16 v[132:135], v[68:71], v[232:235], v[132:135]
    ds_read_b64_tr_b16 v[108:109], v43 offset:24576
    ds_read_b64_tr_b16 v[110:111], v43 offset:28672
    v_mfma_f32_16x16x32_bf16 v[136:139], v[72:75], v[232:235], v[136:139]
    ds_read_b64_tr_b16 v[112:113], v44 offset:24576
    ds_read_b64_tr_b16 v[114:115], v44 offset:28672
    v_mfma_f32_16x16x32_bf16 v[140:143], v[76:79], v[232:235], v[140:143]
    ds_read_b64_tr_b16 v[116:117], v45 offset:24576
    ds_read_b64_tr_b16 v[118:119], v45 offset:28672
    s_add_u32 s67, s67, 2048
    s_and_b32 s67, s67, 16383
    v_add_u32 v26, s67, v5
    v_mfma_f32_16x16x32_bf16 v[144:147], v[80:83], v[232:235], v[144:147]
    ds_read_b64_tr_b16 v[120:121], v46 offset:24576
    ds_read_b64_tr_b16 v[122:123], v46 offset:28672
    s_waitcnt lgkmcnt(12)
    v_mfma_f32_16x16x32_bf16 v[148:151], v[84:87], v[232:235], v[148:151]
    ds_read_b64_tr_b16 v[124:125], v47 offset:24576
    ds_read_b64_tr_b16 v[126:127], v47 offset:28672
    v_mfma_f32_16x16x32_bf16 v[152:155], v[88:91], v[232:235], v[152:155]
    v_mfma_f32_16x16x32_bf16 v[156:159], v[92:95], v[232:235], v[156:159]
    s_add_u32 s67, s67, 2048
    s_and_b32 s67, s67, 16383
    v_add_u32 v27, s67, v5
    v_mfma_f32_16x16x32_bf16 v[128:131], v[96:99], v[236:239], v[128:131]
    s_waitcnt lgkmcnt(6)
    v_mfma_f32_16x16x32_bf16 v[132:135], v[100:103], v[236:239], v[132:135]
    v_mfma_f32_16x16x32_bf16 v[136:139], v[104:107], v[236:239], v[136:139]
    v_mfma_f32_16x16x32_bf16 v[140:143], v[108:111], v[236:239], v[140:143]
    s_add_u32 s67, s67, 2048
    s_and_b32 s67, s67, 16383
    v_add_u32 v28, s67, v5
    v_mfma_f32_16x16x32_bf16 v[144:147], v[112:115], v[236:239], v[144:147]
    s_waitcnt lgkmcnt(0)
    v_mfma_f32_16x16x32_bf16 v[148:151], v[116:119], v[236:239], v[148:151]
    v_mfma_f32_16x16x32_bf16 v[152:155], v[120:123], v[236:239], v[152:155]
    v_mfma_f32_16x16x32_bf16 v[156:159], v[124:127], v[236:239], v[156:159]
    s_add_u32 s67, s67, 2048
    s_and_b32 s67, s67, 16383
    v_add_u32 v29, s67, v5
    s_waitcnt lgkmcnt(0)
    s_barrier
    ds_read_b64_tr_b16 v[64:65], v40 offset:32768
    ds_read_b64_tr_b16 v[66:67], v40 offset:36864
    ds_read_b64_tr_b16 v[68:69], v41 offset:32768
    ds_read_b64_tr_b16 v[70:71], v41 offset:36864
    ds_read_b64_tr_b16 v[72:73], v42 offset:32768
    ds_read_b64_tr_b16 v[74:75], v42 offset:36864
    ds_read_b64_tr_b16 v[76:77], v43 offset:32768
    ds_read_b64_tr_b16 v[78:79], v43 offset:36864
    ds_read_b64_tr_b16 v[80:81], v44 offset:32768
    ds_read_b64_tr_b16 v[82:83], v44 offset:36864
    ds_read_b64_tr_b16 v[84:85], v45 offset:32768
    ds_read_b64_tr_b16 v[86:87], v45 offset:36864
    ds_read_b64_tr_b16 v[88:89], v46 offset:32768
    s_branch L_pad3x
.p2align 12
L_pad3:
    s_setpc_b64 s[78:79]
    s_nop 0
L_pad3x:
    ds_read_b64_tr_b16 v[90:91], v46 offset:36864
    ds_read_b64_tr_b16 v[92:93], v47 offset:32768
    ds_read_b64_tr_b16 v[94:95], v47 offset:36864
    ds_read_b64_tr_b16 v[96:97], v40 offset:40960
    ds_read_b64_tr_b16 v[98:99], v40 offset:45056
    ds_read_b64_tr_b16 v[100:101], v41 offset:40960
    ds_read_b64_tr_b16 v[102:103], v41 offset:45056
    s_cmp_lg_u32 s78, 0
    s_cbranch_scc1 Ly_6r
Ly_6:
    s_waitcnt lgkmcnt(15)
    v_mfma_f32_16x16x32_bf16 v[128:131], v[64:67], v[240:243], v[128:131]
    ds_read_b64_tr_b16 v[104:105], v42 offset:40960
    ds_read_b64_tr_b16 v[106:107], v42 offset:45056
    s_waitcnt lgkmcnt(12)
    v_mfma_f32_16x16x32_bf16 v[132:135], v[68:71], v[240:243], v[132:135]
    ds_read_b64_tr_b16 v[108:109], v43 offset:40960
    ds_read_b64_tr_b16 v[110:111], v43 offset:45056
    v_mfma_f32_16x16x32_bf16 v[136:139], v[72:75], v[240:243], v[136:139]
    ds_read_b64_tr_b16 v[112:113], v44 offset:40960
    ds_read_b64_tr_b16 v[114:115], v44 offset:45056
    v_mfma_f32_16x16x32_bf16 v[140:143], v[76:79], v[240:243], v[140:143]
    ds_read_b64_tr_b16 v[116:117], v45 offset:40960
    ds_read_b64_tr_b16 v[118:119], v45 offset:45056
    v_mfma_f32_16x16x32_bf16 v[144:147], v[80:83], v[240:243], v[144:147]
    ds_read_b64_tr_b16 v[120:121], v46 offset:40960
    ds_read_b64_tr_b16 v[122:123], v46 offset:45056
    s_waitcnt lgkmcnt(12)
    v_mfma_f32_16x16x32_bf16 v[148:151], v[84:87], v[240:243], v[148:151]
    ds_read_b64_tr_b16 v[124:125], v47 offset:40960
    ds_read_b64_tr_b16 v[126:127], v47 offset:45056
    v_mfma_f32_16x16x32_bf16 v[152:155], v[88:91], v[240:243], v[152:155]
    v_mfma_f32_16x16x32_bf16 v[156:159], v[92:95], v[240:243], v[156:159]
    v_mfma_f32_16x16x32_bf16 v[128:131], v[96:99], v[244:247], v[128:131]
    s_waitcnt lgkmcnt(6)
    v_mfma_f32_16x16x32_bf16 v[132:135], v[100:103], v[244:247], v[132:135]
    v_mfma_f32_16x16x32_bf16 v[136:139], v[104:107], v[244:247], v[136:139]
    v_mfma_f32_16x16x32_bf16 v[140:143], v[108:111], v[244:247], v[140:143]
    v_mfma_f32_16x16x32_bf16 v[144:147], v[112:115], v[244:247], v[144:147]
    s_waitcnt lgkmcnt(0)
    v_mfma_f32_16x16x32_bf16 v[148:151], v[116:119], v[244:247], v[148:151]
    v_mfma_f32_16x16x32_bf16 v[152:155], v[120:123], v[244:247], v[152:155]
    v_mfma_f32_16x16x32_bf16 v[156:159], v[124:127], v[244:247], v[156:159]
    v_rcp_f32 v10, v52
    s_waitcnt lgkmcnt(0)
    s_barrier
    ds_read_b64_tr_b16 v[64:65], v40 offset:49152
    ds_read_b64_tr_b16 v[66:67], v40 offset:53248
    ds_read_b64_tr_b16 v[68:69], v41 offset:49152
    ds_read_b64_tr_b16 v[70:71], v41 offset:53248
    ds_read_b64_tr_b16 v[72:73], v42 offset:49152
    ds_read_b64_tr_b16 v[74:75], v42 offset:53248
    ds_read_b64_tr_b16 v[76:77], v43 offset:49152
    ds_read_b64_tr_b16 v[78:79], v43 offset:53248
    ds_read_b64_tr_b16 v[80:81], v44 offset:49152
    ds_read_b64_tr_b16 v[82:83], v44 offset:53248
    ds_read_b64_tr_b16 v[84:85], v45 offset:49152
    ds_read_b64_tr_b16 v[86:87], v45 offset:53248
    ds_read_b64_tr_b16 v[88:89], v46 offset:49152
    ds_read_b64_tr_b16 v[90:91], v46 offset:53248
    ds_read_b64_tr_b16 v[92:93], v47 offset:49152
    ds_read_b64_tr_b16 v[94:95], v47 offset:53248
    ds_read_b64_tr_b16 v[96:97], v40 offset:57344
    ds_read_b64_tr_b16 v[98:99], v40 offset:61440
    ds_read_b64_tr_b16 v[100:101], v41 offset:57344
    ds_read_b64_tr_b16 v[102:103], v41 offset:61440
    s_waitcnt lgkmcnt(15)
    v_mfma_f32_16x16x32_bf16 v[128:131], v[64:67], v[248:251], v[128:131]
    ds_read_b64_tr_b16 v[104:105], v42 offset:57344
    ds_read_b64_tr_b16 v[106:107], v42 offset:61440
    s_waitcnt lgkmcnt(12)
    v_mfma_f32_16x16x32_bf16 v[132:135], v[68:71], v[248:251], v[132:135]
    ds_read_b64_tr_b16 v[108:109], v43 offset:57344
    ds_read_b64_tr_b16 v[110:111], v43 offset:61440
    v_mfma_f32_16x16x32_bf16 v[136:139], v[72:75], v[248:251], v[136:139]
    ds_read_b64_tr_b16 v[112:113], v44 offset:57344
    ds_read_b64_tr_b16 v[114:115], v44 offset:61440
    v_mfma_f32_16x16x32_bf16 v[140:143], v[76:79], v[248:251], v[140:143]
    ds_read_b64_tr_b16 v[116:117], v45 offset:57344
    ds_read_b64_tr_b16 v[118:119], v45 offset:61440
    v_mfma_f32_16x16x32_bf16 v[144:147], v[80:83], v[248:251], v[144:147]
    ds_read_b64_tr_b16 v[120:121], v46 offset:57344
    ds_read_b64_tr_b16 v[122:123], v46 offset:61440
    s_waitcnt lgkmcnt(12)
    v_mfma_f32_16x16x32_bf16 v[148:151], v[84:87], v[248:251], v[148:151]
    ds_read_b64_tr_b16 v[124:125], v47 offset:57344
    ds_read_b64_tr_b16 v[126:127], v47 offset:61440
    v_mfma_f32_16x16x32_bf16 v[152:155], v[88:91], v[248:251], v[152:155]
    v_mfma_f32_16x16x32_bf16 v[156:159], v[92:95], v[248:251], v[156:159]
    v_mfma_f32_16x16x32_bf16 v[128:131], v[96:99], v[252:255], v[128:131]
    s_waitcnt lgkmcnt(6)
    v_mfma_f32_16x16x32_bf16 v[132:135], v[100:103], v[252:255], v[132:135]
    v_mfma_f32_16x16x32_bf16 v[136:139], v[104:107], v[252:255], v[136:139]
    v_mfma_f32_16x16x32_bf16 v[140:143], v[108:111], v[252:255], v[140:143]
    v_mfma_f32_16x16x32_bf16 v[144:147], v[112:115], v[252:255], v[144:147]
    s_waitcnt lgkmcnt(0)
    v_mfma_f32_16x16x32_bf16 v[148:151], v[116:119], v[252:255], v[148:151]
    v_mfma_f32_16x16x32_bf16 v[152:155], v[120:123], v[252:255], v[152:155]
    v_mfma_f32_16x16x32_bf16 v[156:159], v[124:127], v[252:255], v[156:159]
    s_waitcnt vmcnt(0)
    v_pk_mul_f32 v[128:129], v[128:129], v[10:11] op_sel:[0,0] op_sel_hi:[1,0]
    v_pk_mul_f32 v[130:131], v[130:131], v[10:11] op_sel:[0,0] op_sel_hi:[1,0]
    v_cvt_pk_bf16_f32 v128, v128, v129
    v_cvt_pk_bf16_f32 v129, v130, v131
    ds_write_b64 v6, v[128:129] offset:0
    v_pk_mul_f32 v[132:133], v[132:133], v[10:11] op_sel:[0,0] op_sel_hi:[1,0]
    v_pk_mul_f32 v[134:135], v[134:135], v[10:11] op_sel:[0,0] op_sel_hi:[1,0]
    v_cvt_pk_bf16_f32 v132, v132, v133
    v_cvt_pk_bf16_f32 v133, v134, v135
    ds_write_b64 v6, v[132:133] offset:1024
    v_pk_mul_f32 v[136:137], v[136:137], v[10:11] op_sel:[0,0] op_sel_hi:[1,0]
    v_pk_mul_f32 v[138:139], v[138:139], v[10:11] op_sel:[0,0] op_sel_hi:[1,0]
    v_cvt_pk_bf16_f32 v136, v136, v137
    v_cvt_pk_bf16_f32 v137, v138, v139
    ds_write_b64 v6, v[136:137] offset:2048
    v_pk_mul_f32 v[140:141], v[140:141], v[10:11] op_sel:[0,0] op_sel_hi:[1,0]
    v_pk_mul_f32 v[142:143], v[142:143], v[10:11] op_sel:[0,0] op_sel_hi:[1,0]
    v_cvt_pk_bf16_f32 v140, v140, v141
    v_cvt_pk_bf16_f32 v141, v142, v143
    ds_write_b64 v6, v[140:141] offset:3072
    v_pk_mul_f32 v[144:145], v[144:145], v[10:11] op_sel:[0,0] op_sel_hi:[1,0]
    v_pk_mul_f32 v[146:147], v[146:147], v[10:11] op_sel:[0,0] op_sel_hi:[1,0]
    v_cvt_pk_bf16_f32 v144, v144, v145
    v_cvt_pk_bf16_f32 v145, v146, v147
    ds_write_b64 v6, v[144:145] offset:4096
    v_pk_mul_f32 v[148:149], v[148:149], v[10:11] op_sel:[0,0] op_sel_hi:[1,0]
    v_pk_mul_f32 v[150:151], v[150:151], v[10:11] op_sel:[0,0] op_sel_hi:[1,0]
    v_cvt_pk_bf16_f32 v148, v148, v149
    v_cvt_pk_bf16_f32 v149, v150, v151
    ds_write_b64 v6, v[148:149] offset:5120
    v_pk_mul_f32 v[152:153], v[152:153], v[10:11] op_sel:[0,0] op_sel_hi:[1,0]
    v_pk_mul_f32 v[154:155], v[154:155], v[10:11] op_sel:[0,0] op_sel_hi:[1,0]
    v_cvt_pk_bf16_f32 v152, v152, v153
    v_cvt_pk_bf16_f32 v153, v154, v155
    ds_write_b64 v6, v[152:153] offset:6144
    v_pk_mul_f32 v[156:157], v[156:157], v[10:11] op_sel:[0,0] op_sel_hi:[1,0]
    v_pk_mul_f32 v[158:159], v[158:159], v[10:11] op_sel:[0,0] op_sel_hi:[1,0]
    v_cvt_pk_bf16_f32 v156, v156, v157
    v_cvt_pk_bf16_f32 v157, v158, v159
    ds_write_b64 v6, v[156:157] offset:7168
    s_waitcnt lgkmcnt(0)
    s_barrier
    ds_read_b64_tr_b16 v[64:65], v18 offset:16384
    ds_read_b64_tr_b16 v[66:67], v18 offset:18432
    ds_read_b64_tr_b16 v[68:69], v21 offset:16384
    ds_read_b64_tr_b16 v[70:71], v21 offset:18432
    ds_read_b64_tr_b16 v[72:73], v18 offset:20480
    ds_read_b64_tr_b16 v[74:75], v18 offset:22528
    ds_read_b64_tr_b16 v[76:77], v21 offset:20480
    ds_read_b64_tr_b16 v[78:79], v21 offset:22528
    ds_read_b64_tr_b16 v[80:81], v16 offset:0
    ds_read_b64_tr_b16 v[82:83], v16 offset:2048
    ds_read_b64_tr_b16 v[84:85], v19 offset:0
    ds_read_b64_tr_b16 v[86:87], v19 offset:2048
    ds_read_b64_tr_b16 v[88:89], v16 offset:4096
    ds_read_b64_tr_b16 v[90:91], v16 offset:6144
    ds_read_b64_tr_b16 v[92:93], v19 offset:4096
    ds_read_b64_tr_b16 v[94:95], v19 offset:6144
    ds_read_b128 v[192:195], v22 offset:0
    ds_read_b128 v[196:199], v22 offset:1024
    ds_read_b128 v[200:203], v23 offset:0
    ds_read_b128 v[204:207], v23 offset:1024
    s_waitcnt lgkmcnt(0)
    s_barrier
    v_mfma_f32_32x32x16_bf16 v[160:175], v[64:67], v[192:195], 0
    ds_read_b64_tr_b16 v[96:97], v16 offset:16384
    ds_read_b64_tr_b16 v[98:99], v16 offset:18432
    v_mfma_f32_32x32x16_bf16 v[176:191], v[68:71], v[192:195], 0
    ds_read_b64_tr_b16 v[100:101], v19 offset:16384
    ds_read_b64_tr_b16 v[102:103], v19 offset:18432
    ds_read_b64_tr_b16 v[104:105], v16 offset:20480
    ds_read_b64_tr_b16 v[106:107], v16 offset:22528
    v_mfma_f32_32x32x16_bf16 v[160:175], v[72:75], v[196:199], v[160:175]
    ds_read_b64_tr_b16 v[108:109], v19 offset:20480
    ds_read_b64_tr_b16 v[110:111], v19 offset:22528
    v_mfma_f32_32x32x16_bf16 v[176:191], v[76:79], v[196:199], v[176:191]
    ds_read_b64_tr_b16 v[112:113], v16 offset:32768
    ds_read_b64_tr_b16 v[114:115], v16 offset:34816
    ds_read_b64_tr_b16 v[116:117], v19 offset:32768
    ds_read_b64_tr_b16 v[118:119], v19 offset:34816
    v_mfma_f32_32x32x16_bf16 v[160:175], v[80:83], v[200:203], v[160:175]
    ds_read_b64_tr_b16 v[120:121], v16 offset:36864
    ds_read_b64_tr_b16 v[122:123], v16 offset:38912
    v_mfma_f32_32x32x16_bf16 v[176:191], v[84:87], v[200:203], v[176:191]
    ds_read_b64_tr_b16 v[124:125], v19 offset:36864
    ds_read_b64_tr_b16 v[126:127], v19 offset:38912
    ds_read_b128 v[208:211], v24 offset:0
    v_mfma_f32_32x32x16_bf16 v[160:175], v[88:91], v[204:207], v[160:175]
    ds_read_b128 v[212:215], v24 offset:1024
    v_mfma_f32_32x32x16_bf16 v[176:191], v[92:95], v[204:207], v[176:191]
    ds_read_b128 v[216:219], v25 offset:0
    ds_read_b128 v[220:223], v25 offset:1024
    s_waitcnt lgkmcnt(0)
    s_barrier
    v_mfma_f32_32x32x16_bf16 v[160:175], v[96:99], v[208:211], v[160:175]
    ds_read_b64_tr_b16 v[64:65], v16 offset:49152
    ds_read_b64_tr_b16 v[66:67], v16 offset:51200
    v_mfma_f32_32x32x16_bf16 v[176:191], v[100:103], v[208:211], v[176:191]
    ds_read_b64_tr_b16 v[68:69], v19 offset:49152
    ds_read_b64_tr_b16 v[70:71], v19 offset:51200
    ds_read_b64_tr_b16 v[72:73], v16 offset:53248
    ds_read_b64_tr_b16 v[74:75], v16 offset:55296
    v_mfma_f32_32x32x16_bf16 v[160:175], v[104:107], v[212:215], v[160:175]
    ds_read_b64_tr_b16 v[76:77], v19 offset:53248
    ds_read_b64_tr_b16 v[78:79], v19 offset:55296
    v_mfma_f32_32x32x16_bf16 v[176:191], v[108:111], v[212:215], v[176:191]
    ds_read_b64_tr_b16 v[80:81], v17 offset:0
    ds_read_b64_tr_b16 v[82:83], v17 offset:2048
    ds_read_b64_tr_b16 v[84:85], v20 offset:0
    ds_read_b64_tr_b16 v[86:87], v20 offset:2048
    v_mfma_f32_32x32x16_bf16 v[160:175], v[112:115], v[216:219], v[160:175]
    ds_read_b64_tr_b16 v[88:89], v17 offset:4096
    ds_read_b64_tr_b16 v[90:91], v17 offset:6144
    v_mfma_f32_32x32x16_bf16 v[176:191], v[116:119], v[216:219], v[176:191]
    ds_read_b64_tr_b16 v[92:93], v20 offset:4096
    ds_read_b64_tr_b16 v[94:95], v20 offset:6144
    ds_read_b128 v[224:227], v26 offset:0
    v_mfma_f32_32x32x16_bf16 v[160:175], v[120:123], v[220:223], v[160:175]
    ds_read_b128 v[228:231], v26 offset:1024
    v_mfma_f32_32x32x16_bf16 v[176:191], v[124:127], v[220:223], v[176:191]
    ds_read_b128 v[232:235], v27 offset:0
    ds_read_b128 v[236:239], v27 offset:1024
    s_waitcnt lgkmcnt(0)
    s_barrier
    v_mfma_f32_32x32x16_bf16 v[160:175], v[64:67], v[224:227], v[160:175]
    ds_read_b64_tr_b16 v[96:97], v17 offset:16384
    ds_read_b64_tr_b16 v[98:99], v17 offset:18432
    v_mfma_f32_32x32x16_bf16 v[176:191], v[68:71], v[224:227], v[176:191]
    ds_read_b64_tr_b16 v[100:101], v20 offset:16384
    ds_read_b64_tr_b16 v[102:103], v20 offset:18432
    ds_read_b64_tr_b16 v[104:105], v17 offset:20480
    ds_read_b64_tr_b16 v[106:107], v17 offset:22528
    v_mfma_f32_32x32x16_bf16 v[160:175], v[72:75], v[228:231], v[160:175]
    ds_read_b64_tr_b16 v[108:109], v20 offset:20480
    ds_read_b64_tr_b16 v[110:111], v20 offset:22528
    v_mfma_f32_32x32x16_bf16 v[176:191], v[76:79], v[228:231], v[176:191]
    ds_read_b64_tr_b16 v[112:113], v17 offset:32768
    ds_read_b64_tr_b16 v[114:115], v17 offset:34816
    ds_read_b64_tr_b16 v[116:117], v20 offset:32768
    ds_read_b64_tr_b16 v[118:119], v20 offset:34816
    v_mfma_f32_32x32x16_bf16 v[160:175], v[80:83], v[232:235], v[160:175]
    ds_read_b64_tr_b16 v[120:121], v17 offset:36864
    ds_read_b64_tr_b16 v[122:123], v17 offset:38912
    v_mfma_f32_32x32x16_bf16 v[176:191], v[84:87], v[232:235], v[176:191]
    ds_read_b64_tr_b16 v[124:125], v20 offset:36864
    ds_read_b64_tr_b16 v[126:127], v20 offset:38912
    ds_read_b128 v[240:243], v28 offset:0
    v_mfma_f32_32x32x16_bf16 v[160:175], v[88:91], v[236:239], v[160:175]
    ds_read_b128 v[244:247], v28 offset:1024
    v_mfma_f32_32x32x16_bf16 v[176:191], v[92:95], v[236:239], v[176:191]
    ds_read_b128 v[248:251], v29 offset:0
    ds_read_b128 v[252:255], v29 offset:1024
    s_waitcnt lgkmcnt(0)
    s_barrier
    v_mfma_f32_32x32x16_bf16 v[160:175], v[96:99], v[240:243], v[160:175]
    ds_read_b64_tr_b16 v[64:65], v17 offset:49152
    ds_read_b64_tr_b16 v[66:67], v17 offset:51200
    v_mfma_f32_32x32x16_bf16 v[176:191], v[100:103], v[240:243], v[176:191]
    ds_read_b64_tr_b16 v[68:69], v20 offset:49152
    ds_read_b64_tr_b16 v[70:71], v20 offset:51200
    v_mfma_f32_32x32x16_bf16 v[160:175], v[104:107], v[244:247], v[160:175]
    ds_read_b64_tr_b16 v[72:73], v17 offset:53248
    ds_read_b64_tr_b16 v[74:75], v17 offset:55296
    v_mfma_f32_32x32x16_bf16 v[176:191], v[108:111], v[244:247], v[176:191]
    ds_read_b64_tr_b16 v[76:77], v20 offset:53248
    ds_read_b64_tr_b16 v[78:79], v20 offset:55296
    v_mfma_f32_32x32x16_bf16 v[160:175], v[112:115], v[248:251], v[160:175]
    ds_read_b64_tr_b16 v[80:81], v18 offset:16384
    ds_read_b64_tr_b16 v[82:83], v18 offset:18432
    v_mfma_f32_32x32x16_bf16 v[176:191], v[116:119], v[248:251], v[176:191]
    ds_read_b64_tr_b16 v[84:85], v21 offset:16384
    ds_read_b64_tr_b16 v[86:87], v21 offset:18432
    v_mfma_f32_32x32x16_bf16 v[160:175], v[120:123], v[252:255], v[160:175]
    ds_read_b64_tr_b16 v[88:89], v18 offset:20480
    ds_read_b64_tr_b16 v[90:91], v18 offset:22528
    v_mfma_f32_32x32x16_bf16 v[176:191], v[124:127], v[252:255], v[176:191]
    ds_read_b64_tr_b16 v[92:93], v21 offset:20480
    ds_read_b64_tr_b16 v[94:95], v21 offset:22528
    s_waitcnt lgkmcnt(0)
    s_barrier
    v_mfma_f32_32x32x16_bf16 v[128:143], v[64:67], v[192:195], 0
    ds_read_b64_tr_b16 v[96:97], v16 offset:0
    ds_read_b64_tr_b16 v[98:99], v16 offset:2048
    v_mfma_f32_32x32x16_bf16 v[144:159], v[68:71], v[192:195], 0
    ds_read_b64_tr_b16 v[100:101], v19 offset:0
    ds_read_b64_tr_b16 v[102:103], v19 offset:2048
    v_mfma_f32_32x32x16_bf16 v[128:143], v[72:75], v[196:199], v[128:143]
    ds_read_b64_tr_b16 v[104:105], v16 offset:4096
    ds_read_b64_tr_b16 v[106:107], v16 offset:6144
    v_cvt_pk_bf16_f32 v160, v160, v161
    v_cvt_pk_bf16_f32 v161, v162, v163
    v_cvt_pk_bf16_f32 v162, v164, v165
    v_mfma_f32_32x32x16_bf16 v[144:159], v[76:79], v[196:199], v[144:159]
    ds_read_b64_tr_b16 v[108:109], v19 offset:4096
    ds_read_b64_tr_b16 v[110:111], v19 offset:6144
    v_cvt_pk_bf16_f32 v163, v166, v167
    buffer_store_dwordx4 v[160:163], v4, s[48:51], s72 offen offset:0 sc1
    v_cvt_pk_bf16_f32 v168, v168, v169
    v_mfma_f32_32x32x16_bf16 v[128:143], v[80:83], v[200:203], v[128:143]
    ds_read_b64_tr_b16 v[112:113], v16 offset:16384
    ds_read_b64_tr_b16 v[114:115], v16 offset:18432
    v_cvt_pk_bf16_f32 v169, v170, v171
    v_cvt_pk_bf16_f32 v170, v172, v173
    v_cvt_pk_bf16_f32 v171, v174, v175
    buffer_store_dwordx4 v[168:171], v4, s[48:51], s72 offen offset:256 sc1
    v_mfma_f32_32x32x16_bf16 v[144:159], v[84:87], v[200:203], v[144:159]
    ds_read_b64_tr_b16 v[116:117], v19 offset:16384
    ds_read_b64_tr_b16 v[118:119], v19 offset:18432
    v_cvt_pk_bf16_f32 v176, v176, v177
    v_cvt_pk_bf16_f32 v177, v178, v179
    v_cvt_pk_bf16_f32 v178, v180, v181
    v_mfma_f32_32x32x16_bf16 v[128:143], v[88:91], v[204:207], v[128:143]
    ds_read_b64_tr_b16 v[120:121], v16 offset:20480
    ds_read_b64_tr_b16 v[122:123], v16 offset:22528
    v_cvt_pk_bf16_f32 v179, v182, v183
    buffer_store_dwordx4 v[176:179], v4, s[48:51], s72 offen offset:512 sc1
    v_cvt_pk_bf16_f32 v184, v184, v185
    v_mfma_f32_32x32x16_bf16 v[144:159], v[92:95], v[204:207], v[144:159]
    ds_read_b64_tr_b16 v[124:125], v19 offset:20480
    ds_read_b64_tr_b16 v[126:127], v19 offset:22528
    v_cvt_pk_bf16_f32 v185, v186, v187
    v_cvt_pk_bf16_f32 v186, v188, v189
    v_cvt_pk_bf16_f32 v187, v190, v191
    buffer_store_dwordx4 v[184:187], v4, s[48:51], s72 offen offset:768 sc1
    s_waitcnt lgkmcnt(0)
    s_barrier
    v_mfma_f32_32x32x16_bf16 v[128:143], v[96:99], v[208:211], v[128:143]
    ds_read_b64_tr_b16 v[64:65], v16 offset:32768
    ds_read_b64_tr_b16 v[66:67], v16 offset:34816
    v_mfma_f32_32x32x16_bf16 v[144:159], v[100:103], v[208:211], v[144:159]
    ds_read_b64_tr_b16 v[68:69], v19 offset:32768
    ds_read_b64_tr_b16 v[70:71], v19 offset:34816
    v_mfma_f32_32x32x16_bf16 v[128:143], v[104:107], v[212:215], v[128:143]
    ds_read_b64_tr_b16 v[72:73], v16 offset:36864
    ds_read_b64_tr_b16 v[74:75], v16 offset:38912
    v_mfma_f32_32x32x16_bf16 v[144:159], v[108:111], v[212:215], v[144:159]
    ds_read_b64_tr_b16 v[76:77], v19 offset:36864
    ds_read_b64_tr_b16 v[78:79], v19 offset:38912
    v_mfma_f32_32x32x16_bf16 v[128:143], v[112:115], v[216:219], v[128:143]
    ds_read_b64_tr_b16 v[80:81], v16 offset:49152
    ds_read_b64_tr_b16 v[82:83], v16 offset:51200
    v_mfma_f32_32x32x16_bf16 v[144:159], v[116:119], v[216:219], v[144:159]
    ds_read_b64_tr_b16 v[84:85], v19 offset:49152
    ds_read_b64_tr_b16 v[86:87], v19 offset:51200
    v_mfma_f32_32x32x16_bf16 v[128:143], v[120:123], v[220:223], v[128:143]
    ds_read_b64_tr_b16 v[88:89], v16 offset:53248
    ds_read_b64_tr_b16 v[90:91], v16 offset:55296
    v_mfma_f32_32x32x16_bf16 v[144:159], v[124:127], v[220:223], v[144:159]
    ds_read_b64_tr_b16 v[92:93], v19 offset:53248
    ds_read_b64_tr_b16 v[94:95], v19 offset:55296
    v_mov_b32 v8, 0
    v_mov_b32 v9, 0
    v_mov_b32 v7, 131072
    ds_write_b64 v7, v[8:9]
    s_waitcnt lgkmcnt(0)
    s_barrier
    v_mfma_f32_32x32x16_bf16 v[128:143], v[64:67], v[224:227], v[128:143]
    ds_read_b64_tr_b16 v[96:97], v17 offset:0
    ds_read_b64_tr_b16 v[98:99], v17 offset:2048
    v_mfma_f32_32x32x16_bf16 v[144:159], v[68:71], v[224:227], v[144:159]
    ds_read_b64_tr_b16 v[100:101], v20 offset:0
    ds_read_b64_tr_b16 v[102:103], v20 offset:2048
    v_mfma_f32_32x32x16_bf16 v[128:143], v[72:75], v[228:231], v[128:143]
    ds_read_b64_tr_b16 v[104:105], v17 offset:4096
    ds_read_b64_tr_b16 v[106:107], v17 offset:6144
    v_mfma_f32_32x32x16_bf16 v[144:159], v[76:79], v[228:231], v[144:159]
    ds_read_b64_tr_b16 v[108:109], v20 offset:4096
    ds_read_b64_tr_b16 v[110:111], v20 offset:6144
    v_mfma_f32_32x32x16_bf16 v[128:143], v[80:83], v[232:235], v[128:143]
    ds_read_b64_tr_b16 v[112:113], v17 offset:16384
    ds_read_b64_tr_b16 v[114:115], v17 offset:18432
    v_mfma_f32_32x32x16_bf16 v[144:159], v[84:87], v[232:235], v[144:159]
    ds_read_b64_tr_b16 v[116:117], v20 offset:16384
    ds_read_b64_tr_b16 v[118:119], v20 offset:18432
    v_mfma_f32_32x32x16_bf16 v[128:143], v[88:91], v[236:239], v[128:143]
    ds_read_b64_tr_b16 v[120:121], v17 offset:20480
    ds_read_b64_tr_b16 v[122:123], v17 offset:22528
    v_mfma_f32_32x32x16_bf16 v[144:159], v[92:95], v[236:239], v[144:159]
    ds_read_b64_tr_b16 v[124:125], v20 offset:20480
    ds_read_b64_tr_b16 v[126:127], v20 offset:22528
    s_waitcnt lgkmcnt(0)
    v_mfma_f32_32x32x16_bf16 v[128:143], v[96:99], v[240:243], v[128:143]
    v_mfma_f32_32x32x16_bf16 v[128:143], v[104:107], v[244:247], v[128:143]
    v_mfma_f32_32x32x16_bf16 v[128:143], v[112:115], v[248:251], v[128:143]
    v_mfma_f32_32x32x16_bf16 v[128:143], v[120:123], v[252:255], v[128:143]
    v_mfma_f32_32x32x16_bf16 v[144:159], v[100:103], v[240:243], v[144:159]
    v_mfma_f32_32x32x16_bf16 v[144:159], v[108:111], v[244:247], v[144:159]
    v_mfma_f32_32x32x16_bf16 v[144:159], v[116:119], v[248:251], v[144:159]
    v_mfma_f32_32x32x16_bf16 v[144:159], v[124:127], v[252:255], v[144:159]
    s_add_u32 s72, s72, 16384
    s_nop 6
    v_cvt_pk_bf16_f32 v128, v128, v129
    v_cvt_pk_bf16_f32 v129, v130, v131
    v_cvt_pk_bf16_f32 v130, v132, v133
    v_cvt_pk_bf16_f32 v131, v134, v135
    buffer_store_dwordx4 v[128:131], v4, s[48:51], s72 offen offset:0 sc1
    v_cvt_pk_bf16_f32 v136, v136, v137
    v_cvt_pk_bf16_f32 v137, v138, v139
    v_cvt_pk_bf16_f32 v138, v140, v141
    v_cvt_pk_bf16_f32 v139, v142, v143
    buffer_store_dwordx4 v[136:139], v4, s[48:51], s72 offen offset:256 sc1
    v_cvt_pk_bf16_f32 v144, v144, v145
    v_cvt_pk_bf16_f32 v145, v146, v147
    v_cvt_pk_bf16_f32 v146, v148, v149
    v_cvt_pk_bf16_f32 v147, v150, v151
    buffer_store_dwordx4 v[144:147], v4, s[48:51], s72 offen offset:512 sc1
    v_cvt_pk_bf16_f32 v152, v152, v153
    v_cvt_pk_bf16_f32 v153, v154, v155
    v_cvt_pk_bf16_f32 v154, v156, v157
    v_cvt_pk_bf16_f32 v155, v158, v159
    buffer_store_dwordx4 v[152:155], v4, s[48:51], s72 offen offset:768 sc1
    s_waitcnt vmcnt(4)
    s_mov_b64 exec, 15
    buffer_store_dword v61, v60, s[48:51], s74 offen sc1
    s_add_u32 s74, s74, 128
    s_mov_b64 exec, -1
    v_and_b32 v23, 15, v1
    v_lshlrev_b32 v24, 2, v23
    v_lshrrev_b32 v25, 4, v1
    v_mul_u32_u24 v26, 1024, v25
    v_lshl_add_u32 v26, v23, 4, v26
    v_and_b32 v27, 7, v1
    v_lshlrev_b32 v27, 10, v27
    v_bfe_u32 v28, v1, 3, 1
    v_lshl_add_u32 v27, v28, 3, v27
    v_lshrrev_b32 v28, 1, v25
    v_lshl_add_u32 v27, v28, 4, v27
    v_and_b32 v28, 1, v25
    v_lshl_add_u32 v27, v28, 2, v27
    s_mul_i32 s64, s53, 524288
    s_mul_i32 s75, s2, 256
    s_add_u32 s75, s75, 16777344
    v_mov_b32 v29, 131076
    v_mov_b32 v22, 1
    s_mul_i32 s65, s56, 32768
    s_add_u32 s65, s65, s64
    s_lshl_b32 s66, s68, 8
    s_add_u32 s65, s65, s66
    s_add_u32 s65, s65, 16384
    s_lshr_b32 s64, s56, 3
    s_lshl_b32 s66, s53, 1
    s_add_u32 s64, s64, s66
    s_add_u32 s64, s64, 2
    s_and_b32 s64, s64, 3
    s_lshl_b32 s64, s64, 8
    s_bfe_u32 s66, s56, 0x10002
    s_lshl_b32 s66, s66, 7
    s_add_u32 s64, s64, s66
    s_lshl_b32 s66, s68, 5
    s_add_u32 s64, s64, s66
    s_lshl_b32 s66, s53, 15
    s_add_u32 s64, s64, s66
    s_and_b32 s66, s56, 3
    s_lshl_b32 s66, s66, 13
    s_add_u32 s64, s64, s66
    s_mov_b32 s67, 0xffff0000
    s_mov_b32 s70, 200000
    s_barrier
    s_waitcnt vmcnt(1)
    s_mov_b64 exec, 15
    buffer_store_dword v61, v60, s[48:51], s74 offen sc1
    s_add_u32 s74, s74, 128
    s_mov_b64 exec, -1
L_poll:
    s_cmp_lg_u32 s68, 0
    s_cbranch_scc1 L_lwait0
L_poll1:
    buffer_load_dword v32, v24, s[48:51], s75 offen sc1
    s_waitcnt vmcnt(0)
    v_cmp_ne_u32 vcc, 1, v32
    s_cbranch_vccz L_got
    s_sub_u32 s70, s70, 1
    s_cmp_lg_u32 s70, 0
    s_cbranch_scc1 L_poll1
L_got:
    ds_write_b32 v29, v22
    s_branch L_polled
L_lwait0:
    s_mov_b32 s70, 2000000
L_lwait:
    ds_read_b32 v32, v29
    s_waitcnt lgkmcnt(0)
    v_cmp_eq_u32 vcc, 1, v32
    s_cbranch_vccnz L_polled
    s_sub_u32 s70, s70, 1
    s_cmp_lg_u32 s70, 0
    s_cbranch_scc1 L_lwait
L_polled:
    s_mov_b32 s70, 200000
L_load:
    buffer_load_dwordx4 v[32:35], v26, s[48:51], s65 offen sc1
    s_add_u32 s65, s65, 4096
    buffer_load_dwordx4 v[36:39], v26, s[48:51], s65 offen sc1
    s_add_u32 s65, s65, 4096
    buffer_load_dwordx4 v[40:43], v26, s[48:51], s65 offen sc1
    s_add_u32 s65, s65, 4096
    buffer_load_dwordx4 v[44:47], v26, s[48:51], s65 offen sc1
    s_sub_u32 s65, s65, 12288
    s_waitcnt vmcnt(3)
    v_lshlrev_b32 v64, 16, v32
    v_and_b32 v65, s67, v32
    v_lshlrev_b32 v66, 16, v33
    v_and_b32 v67, s67, v33
    v_lshlrev_b32 v68, 16, v34
    v_and_b32 v69, s67, v34
    v_lshlrev_b32 v70, 16, v35
    v_and_b32 v71, s67, v35
    s_waitcnt vmcnt(2)
    v_lshlrev_b32 v72, 16, v36
    v_and_b32 v73, s67, v36
    v_lshlrev_b32 v74, 16, v37
    v_and_b32 v75, s67, v37
    v_lshlrev_b32 v76, 16, v38
    v_and_b32 v77, s67, v38
    v_lshlrev_b32 v78, 16, v39
    v_and_b32 v79, s67, v39
    v_add_f32 v64, v64, v72
    v_add_f32 v65, v65, v73
    v_add_f32 v66, v66, v74
    v_add_f32 v67, v67, v75
    v_add_f32 v68, v68, v76
    v_add_f32 v69, v69, v77
    v_add_f32 v70, v70, v78
    v_add_f32 v71, v71, v79
    s_waitcnt vmcnt(1)
    v_lshlrev_b32 v72, 16, v40
    v_and_b32 v73, s67, v40
    v_lshlrev_b32 v74, 16, v41
    v_and_b32 v75, s67, v41
    v_lshlrev_b32 v76, 16, v42
    v_and_b32 v77, s67, v42
    v_lshlrev_b32 v78, 16, v43
    v_and_b32 v79, s67, v43
    v_add_f32 v64, v64, v72
    v_add_f32 v65, v65, v73
    v_add_f32 v66, v66, v74
    v_add_f32 v67, v67, v75
    v_add_f32 v68, v68, v76
    v_add_f32 v69, v69, v77
    v_add_f32 v70, v70, v78
    v_add_f32 v71, v71, v79
    s_waitcnt vmcnt(0)
    v_lshlrev_b32 v72, 16, v44
    v_and_b32 v73, s67, v44
    v_lshlrev_b32 v74, 16, v45
    v_and_b32 v75, s67, v45
    v_lshlrev_b32 v76, 16, v46
    v_and_b32 v77, s67, v46
    v_lshlrev_b32 v78, 16, v47
    v_and_b32 v79, s67, v47
    v_add_f32 v64, v64, v72
    v_add_f32 v65, v65, v73
    v_add_f32 v66, v66, v74
    v_add_f32 v67, v67, v75
    v_add_f32 v68, v68, v76
    v_add_f32 v69, v69, v77
    v_add_f32 v70, v70, v78
    v_add_f32 v71, v71, v79
    v_permlane32_swap_b32 v64, v68
    v_permlane32_swap_b32 v65, v69
    v_permlane32_swap_b32 v66, v70
    v_permlane32_swap_b32 v67, v71
    v_add_f32 v64, v64, v68
    v_add_f32 v65, v65, v69
    v_add_f32 v66, v66, v70
    v_add_f32 v67, v67, v71
    s_nop 0
    v_permlane16_swap_b32 v64, v66
    v_permlane16_swap_b32 v65, v67
    v_add_f32 v64, v64, v66
    v_add_f32 v65, v65, v67
    v_cvt_pk_bf16_f32 v64, v64, v65
    buffer_store_dword v64, v27, s[40:43], s64 offen
    s_endpgm
Lz_1r:
    s_nop 7
    s_mov_b32 s76, 1
    v_mov_b32 v9, v8
    s_nop 1
    v_permlane32_swap_b32 v8, v9
    v_max_f32 v8, v8, v9
    v_mov_b32 v9, v8
    s_nop 1
    v_permlane16_swap_b32 v8, v9
    v_max_f32 v8, v8, v9
    v_max_f32 v8, 0, v8
    v_sub_f32 v12, 0, v8
    v_exp_f32 v12, v12
    v_sub_f32 v56, v56, v8
    v_sub_f32 v57, v57, v8
    v_sub_f32 v58, v58, v8
    v_sub_f32 v59, v59, v8
    v_sub_f32 v160, v160, v8
    v_sub_f32 v161, v161, v8
    v_sub_f32 v162, v162, v8
    v_sub_f32 v163, v163, v8
    v_sub_f32 v164, v164, v8
    v_sub_f32 v165, v165, v8
    v_sub_f32 v166, v166, v8
    v_sub_f32 v167, v167, v8
    v_sub_f32 v168, v168, v8
    v_sub_f32 v169, v169, v8
    v_sub_f32 v170, v170, v8
    v_sub_f32 v171, v171, v8
    v_sub_f32 v172, v172, v8
    v_sub_f32 v173, v173, v8
    v_sub_f32 v174, v174, v8
    v_sub_f32 v175, v175, v8
    v_sub_f32 v176, v176, v8
    v_sub_f32 v177, v177, v8
    v_sub_f32 v178, v178, v8
    v_sub_f32 v179, v179, v8
    v_sub_f32 v180, v180, v8
    v_sub_f32 v181, v181, v8
    v_sub_f32 v182, v182, v8
    v_sub_f32 v183, v183, v8
    v_sub_f32 v184, v184, v8
    v_sub_f32 v185, v185, v8
    v_sub_f32 v186, v186, v8
    v_sub_f32 v187, v187, v8
    v_sub_f32 v188, v188, v8
    v_sub_f32 v189, v189, v8
    s_branch L_pad4x
.p2align 12
L_pad4:
    s_setpc_b64 s[78:79]
    s_nop 0
L_pad4x:
    v_sub_f32 v190, v190, v8
    v_sub_f32 v191, v191, v8
    v_mul_f32 v52, v52, v12
    s_nop 1
    s_branch Lz_1
Lz_2r:
    s_nop 7
    s_mov_b32 s77, 1
    v_mov_b32 v9, v8
    s_nop 1
    v_permlane32_swap_b32 v8, v9
    v_max_f32 v8, v8, v9
    v_mov_b32 v9, v8
    s_nop 1
    v_permlane16_swap_b32 v8, v9
    v_max_f32 v8, v8, v9
    v_max_f32 v8, 0, v8
    v_sub_f32 v13, 0, v8
    v_exp_f32 v13, v13
    v_sub_f32 v56, v56, v8
    v_sub_f32 v57, v57, v8
    v_sub_f32 v58, v58, v8
    v_sub_f32 v59, v59, v8
    v_sub_f32 v128, v128, v8
    v_sub_f32 v129, v129, v8
    v_sub_f32 v130, v130, v8
    v_sub_f32 v131, v131, v8
    v_sub_f32 v132, v132, v8
    v_sub_f32 v133, v133, v8
    v_sub_f32 v134, v134, v8
    v_sub_f32 v135, v135, v8
    v_sub_f32 v136, v136, v8
    v_sub_f32 v137, v137, v8
    v_sub_f32 v138, v138, v8
    v_sub_f32 v139, v139, v8
    v_sub_f32 v140, v140, v8
    v_sub_f32 v141, v141, v8
    v_sub_f32 v142, v142, v8
    v_sub_f32 v143, v143, v8
    v_sub_f32 v144, v144, v8
    v_sub_f32 v145, v145, v8
    v_sub_f32 v146, v146, v8
    v_sub_f32 v147, v147, v8
    v_sub_f32 v148, v148, v8
    v_sub_f32 v149, v149, v8
    v_sub_f32 v150, v150, v8
    v_sub_f32 v151, v151, v8
    v_sub_f32 v152, v152, v8
    v_sub_f32 v153, v153, v8
    v_sub_f32 v154, v154, v8
    v_sub_f32 v155, v155, v8
    v_sub_f32 v156, v156, v8
    v_sub_f32 v157, v157, v8
    v_sub_f32 v158, v158, v8
    v_sub_f32 v159, v159, v8
    v_mul_f32 v52, v52, v13
    s_nop 1
    s_branch Lz_2
Lz_3r:
    s_nop 7
    s_mov_b32 s78, 1
    v_mov_b32 v9, v8
    s_nop 1
    v_permlane32_swap_b32 v8, v9
    v_max_f32 v8, v8, v9
    v_mov_b32 v9, v8
    s_nop 1
    v_permlane16_swap_b32 v8, v9
    v_max_f32 v8, v8, v9
    v_max_f32 v8, 0, v8
    v_sub_f32 v14, 0, v8
    v_exp_f32 v14, v14
    v_sub_f32 v56, v56, v8
    v_sub_f32 v57, v57, v8
    v_sub_f32 v58, v58, v8
    v_sub_f32 v59, v59, v8
    v_sub_f32 v160, v160, v8
    v_sub_f32 v161, v161, v8
    v_sub_f32 v162, v162, v8
    v_sub_f32 v163, v163, v8
    v_sub_f32 v164, v164, v8
    v_sub_f32 v165, v165, v8
    v_sub_f32 v166, v166, v8
    v_sub_f32 v167, v167, v8
    v_sub_f32 v168, v168, v8
    v_sub_f32 v169, v169, v8
    v_sub_f32 v170, v170, v8
    v_sub_f32 v171, v171, v8
    v_sub_f32 v172, v172, v8
    v_sub_f32 v173, v173, v8
    v_sub_f32 v174, v174, v8
    v_sub_f32 v175, v175, v8
    v_sub_f32 v176, v176, v8
    v_sub_f32 v177, v177, v8
    v_sub_f32 v178, v178, v8
    v_sub_f32 v179, v179, v8
    v_sub_f32 v180, v180, v8
    v_sub_f32 v181, v181, v8
    v_sub_f32 v182, v182, v8
    v_sub_f32 v183, v183, v8
    v_sub_f32 v184, v184, v8
    v_sub_f32 v185, v185, v8
    v_sub_f32 v186, v186, v8
    v_sub_f32 v187, v187, v8
    v_sub_f32 v188, v188, v8
    v_sub_f32 v189, v189, v8
    v_sub_f32 v190, v190, v8
    v_sub_f32 v191, v191, v8
    v_mul_f32 v52, v52, v14
    s_nop 1
    s_branch Lz_3
Ly_4r:
    s_nop 7
    v_pk_mul_f32 v[128:129], v[128:129], v[12:13] op_sel:[0,0] op_sel_hi:[1,0]
    v_pk_mul_f32 v[130:131], v[130:131], v[12:13] op_sel:[0,0] op_sel_hi:[1,0]
    v_pk_mul_f32 v[132:133], v[132:133], v[12:13] op_sel:[0,0] op_sel_hi:[1,0]
    v_pk_mul_f32 v[134:135], v[134:135], v[12:13] op_sel:[0,0] op_sel_hi:[1,0]
    v_pk_mul_f32 v[136:137], v[136:137], v[12:13] op_sel:[0,0] op_sel_hi:[1,0]
    v_pk_mul_f32 v[138:139], v[138:139], v[12:13] op_sel:[0,0] op_sel_hi:[1,0]
    v_pk_mul_f32 v[140:141], v[140:141], v[12:13] op_sel:[0,0] op_sel_hi:[1,0]
    v_pk_mul_f32 v[142:143], v[142:143], v[12:13] op_sel:[0,0] op_sel_hi:[1,0]
    v_pk_mul_f32 v[144:145], v[144:145], v[12:13] op_sel:[0,0] op_sel_hi:[1,0]
    v_pk_mul_f32 v[146:147], v[146:147], v[12:13] op_sel:[0,0] op_sel_hi:[1,0]
    v_pk_mul_f32 v[148:149], v[148:149], v[12:13] op_sel:[0,0] op_sel_hi:[1,0]
    v_pk_mul_f32 v[150:151], v[150:151], v[12:13] op_sel:[0,0] op_sel_hi:[1,0]
    v_pk_mul_f32 v[152:153], v[152:153], v[12:13] op_sel:[0,0] op_sel_hi:[1,0]
    v_pk_mul_f32 v[154:155], v[154:155], v[12:13] op_sel:[0,0] op_sel_hi:[1,0]
    v_pk_mul_f32 v[156:157], v[156:157], v[12:13] op_sel:[0,0] op_sel_hi:[1,0]
    v_pk_mul_f32 v[158:159], v[158:159], v[12:13] op_sel:[0,0] op_sel_hi:[1,0]
    s_nop 1
    s_branch Ly_4
Ly_5r:
    s_nop 7
    v_pk_mul_f32 v[128:129], v[128:129], v[12:13] op_sel:[0,1] op_sel_hi:[1,1]
    v_pk_mul_f32 v[130:131], v[130:131], v[12:13] op_sel:[0,1] op_sel_hi:[1,1]
    v_pk_mul_f32 v[132:133], v[132:133], v[12:13] op_sel:[0,1] op_sel_hi:[1,1]
    v_pk_mul_f32 v[134:135], v[134:135], v[12:13] op_sel:[0,1] op_sel_hi:[1,1]
    v_pk_mul_f32 v[136:137], v[136:137], v[12:13] op_sel:[0,1] op_sel_hi:[1,1]
    v_pk_mul_f32 v[138:139], v[138:139], v[12:13] op_sel:[0,1] op_sel_hi:[1,1]
    v_pk_mul_f32 v[140:141], v[140:141], v[12:13] op_sel:[0,1] op_sel_hi:[1,1]
    v_pk_mul_f32 v[142:143], v[142:143], v[12:13] op_sel:[0,1] op_sel_hi:[1,1]
    v_pk_mul_f32 v[144:145], v[144:145], v[12:13] op_sel:[0,1] op_sel_hi:[1,1]
    v_pk_mul_f32 v[146:147], v[146:147], v[12:13] op_sel:[0,1] op_sel_hi:[1,1]
    v_pk_mul_f32 v[148:149], v[148:149], v[12:13] op_sel:[0,1] op_sel_hi:[1,1]
    v_pk_mul_f32 v[150:151], v[150:151], v[12:13] op_sel:[0,1] op_sel_hi:[1,1]
    v_pk_mul_f32 v[152:153], v[152:153], v[12:13] op_sel:[0,1] op_sel_hi:[1,1]
    v_pk_mul_f32 v[154:155], v[154:155], v[12:13] op_sel:[0,1] op_sel_hi:[1,1]
    v_pk_mul_f32 v[156:157], v[156:157], v[12:13] op_sel:[0,1] op_sel_hi:[1,1]
    v_pk_mul_f32 v[158:159], v[158:159], v[12:13] op_sel:[0,1] op_sel_hi:[1,1]
    s_nop 1
    s_branch Ly_5
Ly_6r:
    s_nop 7
    v_pk_mul_f32 v[128:129], v[128:129], v[14:15] op_sel:[0,0] op_sel_hi:[1,0]
    v_pk_mul_f32 v[130:131], v[130:131], v[14:15] op_sel:[0,0] op_sel_hi:[1,0]
    v_pk_mul_f32 v[132:133], v[132:133], v[14:15] op_sel:[0,0] op_sel_hi:[1,0]
    v_pk_mul_f32 v[134:135], v[134:135], v[14:15] op_sel:[0,0] op_sel_hi:[1,0]
    v_pk_mul_f32 v[136:137], v[136:137], v[14:15] op_sel:[0,0] op_sel_hi:[1,0]
    v_pk_mul_f32 v[138:139], v[138:139], v[14:15] op_sel:[0,0] op_sel_hi:[1,0]
    v_pk_mul_f32 v[140:141], v[140:141], v[14:15] op_sel:[0,0] op_sel_hi:[1,0]
    v_pk_mul_f32 v[142:143], v[142:143], v[14:15] op_sel:[0,0] op_sel_hi:[1,0]
    v_pk_mul_f32 v[144:145], v[144:145], v[14:15] op_sel:[0,0] op_sel_hi:[1,0]
    v_pk_mul_f32 v[146:147], v[146:147], v[14:15] op_sel:[0,0] op_sel_hi:[1,0]
    v_pk_mul_f32 v[148:149], v[148:149], v[14:15] op_sel:[0,0] op_sel_hi:[1,0]
    v_pk_mul_f32 v[150:151], v[150:151], v[14:15] op_sel:[0,0] op_sel_hi:[1,0]
    v_pk_mul_f32 v[152:153], v[152:153], v[14:15] op_sel:[0,0] op_sel_hi:[1,0]
    v_pk_mul_f32 v[154:155], v[154:155], v[14:15] op_sel:[0,0] op_sel_hi:[1,0]
    v_pk_mul_f32 v[156:157], v[156:157], v[14:15] op_sel:[0,0] op_sel_hi:[1,0]
    v_pk_mul_f32 v[158:159], v[158:159], v[14:15] op_sel:[0,0] op_sel_hi:[1,0]
    s_nop 1
    s_branch Ly_6
L_end:
    s_endpgm
.section .rodata,"a"
.p2align 6
.amdhsa_kernel standalone__gqa_block_cached__near_ridge_kernel
  .amdhsa_next_free_vgpr 256
  .amdhsa_next_free_sgpr 102
  .amdhsa_accum_offset 256
  .amdhsa_group_segment_fixed_size 0
  .amdhsa_float_denorm_mode_32 3
  .amdhsa_kernarg_size 64
  .amdhsa_user_sgpr_count 2
  .amdhsa_user_sgpr_kernarg_segment_ptr 1
  .amdhsa_system_sgpr_workgroup_id_x 1
.end_amdhsa_kernel
```
